```python
import torch

def _softmax(x, axis=-1):
    return torch.softmax(x, dim=axis)
def _gelu(x):
    return torch.nn.functional.gelu(x, approximate="tanh")
def _silu(x):
    return torch.nn.functional.silu(x)
def _sigmoid(x):
    return torch.sigmoid(x)
def _layernorm(x, axis=-1, eps=1e-5):
    m = x.mean(dim=axis, keepdim=True)
    v = x.var(dim=axis, keepdim=True, unbiased=False)
    return (x - m) / torch.sqrt(v + eps)
def _scatter_add(tgt, idx, src, axis=0):
    return tgt.clone().index_add_(axis, idx, src)
def _segment_sum(src, seg, n):
    out = torch.zeros((n,) + src.shape[1:], dtype=src.dtype)
    return out.index_add_(0, seg, src)
def _pad(x, pw):
    flat = tuple(v for pair in reversed(pw) for v in pair)
    return torch.nn.functional.pad(x, flat)

kernel_name = 'concat_heads__gqa_block_cached__mha_block_cached__near_ridge'

def setup_inputs():

    _w = (lambda a: (lambda t: t.to(torch.bfloat16) if t.is_floating_point() else t)(torch.as_tensor(a)))
    def _A_setup():
        B, Sq, D = 8, 32, 512
        Hq, Hkv, Sk, Dh = 32, 8, 2048, 128
        assert Hq % Hkv == 0, (Hq, Hkv)
        return {
            "x": _w((lambda *s: torch.randn(*s, dtype=torch.bfloat16) * 0.8)(B, Sq, D)),
            "k_cache": _w((lambda *s: torch.randn(*s, dtype=torch.bfloat16) * 0.8)(B, Hkv, Sk, Dh)),
            "v_cache": _w((lambda *s: torch.randn(*s, dtype=torch.bfloat16) * 0.05)(B, Hkv, Sk, Dh)),
            "wq": _w((lambda *s: torch.randn(*s, dtype=torch.bfloat16) * 0.8)(D, Hq * Dh) * (D ** -0.5)),
            "wo": _w((lambda *s: torch.randn(*s, dtype=torch.bfloat16) * 0.05)(Hq * Dh, D) * ((Hq * Dh) ** -0.5)),
        }
    _A_in = _A_setup()

    def _B_setup():
        B, Sq, D = 8, 32, 512
        H, Sk, Dh = 32, 2048, 128
        return {
            "x": _w((lambda *s: torch.randn(*s, dtype=torch.bfloat16) * 0.8)(B, Sq, D)),
            "k_cache": _w((lambda *s: torch.randn(*s, dtype=torch.bfloat16) * 0.8)(B, H, Sk, Dh)),
            "v_cache": _w((lambda *s: torch.randn(*s, dtype=torch.bfloat16) * 0.05)(B, H, Sk, Dh)),
            "wq": _w((lambda *s: torch.randn(*s, dtype=torch.bfloat16) * 0.8)(D, H * Dh) * (D ** -0.5)),
            "wo": _w((lambda *s: torch.randn(*s, dtype=torch.bfloat16) * 0.05)(H * Dh, D) * ((H * Dh) ** -0.5)),
        }
    _B_in = _B_setup()

    return {
        "A_x": _A_in["x"],
        "A_k_cache": _A_in["k_cache"],
        "A_v_cache": _A_in["v_cache"],
        "A_wq": _A_in["wq"],
        "A_wo": _A_in["wo"],
        "B_x": _B_in["x"],
        "B_k_cache": _B_in["k_cache"],
        "B_v_cache": _B_in["v_cache"],
        "B_wq": _B_in["wq"],
        "B_wo": _B_in["wo"],
    }

def reference(A_x, A_k_cache, A_v_cache, A_wq, A_wo, B_x, B_k_cache, B_v_cache, B_wq, B_wo):
    def _A_ref(x, k_cache, v_cache, wq, wo):
        B, Sq, D = x.shape
        Hq, Dh = 32, 128
        Hkv = k_cache.shape[1]
        rep = Hq // Hkv
        q = (lambda x, *d: x.permute(*d))((x @ wq).reshape(B, Sq, Hq, Dh), 0, 2, 1, 3)
        k = (lambda x, n, axis: torch.repeat_interleave(x, n, dim=axis))(k_cache, rep, axis=1)
        v = (lambda x, n, axis: torch.repeat_interleave(x, n, dim=axis))(v_cache, rep, axis=1)
        scores = torch.einsum("bhqd,bhkd->bhqk", q, k) * (Dh ** -0.5)
        p = _softmax(scores, axis=-1)
        o = torch.einsum("bhqk,bhkd->bhqd", p, v)
        return (lambda x, *d: x.permute(*d))(o, 0, 2, 1, 3).reshape(B, Sq, Hq * Dh) @ wo

    def _B_ref(x, k_cache, v_cache, wq, wo):
        B, Sq, D = x.shape
        H, Dh = 32, 128
        q = (lambda x, *d: x.permute(*d))((x @ wq).reshape(B, Sq, H, Dh), 0, 2, 1, 3)
        scores = torch.einsum("bhqd,bhkd->bhqk", q, k_cache) * (Dh ** -0.5)
        p = _softmax(scores, axis=-1)
        o = torch.einsum("bhqk,bhkd->bhqd", p, v_cache)
        return (lambda x, *d: x.permute(*d))(o, 0, 2, 1, 3).reshape(B, Sq, H * Dh) @ wo

    a = _A_ref(A_x, A_k_cache, A_v_cache, A_wq, A_wo)
    b = _B_ref(B_x, B_k_cache, B_v_cache, B_wq, B_wo)
    return torch.concatenate([a, b], axis=-1)
```

```asm
; @launch grid=(512,1,1) block=(256,1,1) lds=81920
.amdgcn_target "amdgcn-amd-amdhsa--gfx950"
.text
.globl concat_heads__gqa_block_cached__mha_block_cached__near_ridge_kernel
.p2align 8
.type concat_heads__gqa_block_cached__mha_block_cached__near_ridge_kernel,@function
concat_heads__gqa_block_cached__mha_block_cached__near_ridge_kernel:
    s_cmp_ge_u32 s2, 512
    s_cbranch_scc1 L_exit
    s_load_dwordx16 s[16:31], s[0:1], 0
    s_load_dwordx8 s[32:39], s[0:1], 64
    s_load_dwordx2 s[40:41], s[0:1], 96
    v_lshrrev_b32 v1, 6, v0
    v_and_b32 v255, 63, v0
    v_readfirstlane_b32 s3, v1
    s_and_b32 s4, s2, 7
    s_lshr_b32 s5, s2, 3
    s_and_b32 s5, s5, 31
    s_mov_b32 s91, 0
    s_setprio 3
    s_waitcnt lgkmcnt(0)
    s_cmp_ge_u32 s2, 256
    s_cbranch_scc1 ROLE_A
ROLE_B:
    s_and_b32 s8, s5, 3
    s_lshr_b32 s6, s5, 2
    s_lshl_b32 s7, s4, 2
    s_add_u32 s7, s7, s8
    s_lshl_b32 s8, s6, 15
    s_add_u32 s44, s26, s8
    s_addc_u32 s45, s27, 0
    s_and_b32 s45, s45, 0xffff
    s_mov_b32 s46, 32768
    s_mov_b32 s47, 0x20000
    s_lshl_b32 s8, s7, 8
    s_add_u32 s48, s32, s8
    s_addc_u32 s49, s33, 0
    s_sub_u32 s9, 4194304, s8
    s_and_b32 s49, s49, 0xffff
    s_mov_b32 s50, s9
    s_mov_b32 s51, 0x20000
    s_and_b32 s67, s6, 3
    s_lshl_b32 s8, s6, 5
    s_add_u32 s8, s8, s7
    s_mov_b32 s86, s8
    s_lshl_b32 s9, s86, 19
    s_lshr_b32 s10, s86, 13
    s_add_u32 s52, s28, s9
    s_addc_u32 s53, s29, s10
    s_and_b32 s53, s53, 0xffff
    s_mov_b32 s54, 524288
    s_mov_b32 s55, 0x20000
    s_add_u32 s56, s30, s9
    s_addc_u32 s57, s31, s10
    s_and_b32 s57, s57, 0xffff
    s_mov_b32 s58, 524288
    s_mov_b32 s59, 0x20000
    s_add_u32 s8, s8, 256
    s_lshl_b32 s8, s8, 13
    s_add_u32 s8, s8, 4194304
    s_add_u32 s70, s40, s8
    s_addc_u32 s71, s41, 0
    v_lshrrev_b32 v244, 4, v255
    v_and_b32 v245, 15, v255
    v_add_u32 v246, 0, v244
    v_xor_b32 v246, v246, v245
    v_lshlrev_b32 v246, 4, v246
    v_lshl_add_u32 v250, v244, 8, v246
    v_add_u32 v246, 4, v244
    v_xor_b32 v246, v246, v245
    v_lshlrev_b32 v246, 4, v246
    v_lshl_add_u32 v251, v244, 8, v246
    v_add_u32 v246, 8, v244
    v_xor_b32 v246, v246, v245
    v_lshlrev_b32 v246, 4, v246
    v_lshl_add_u32 v252, v244, 8, v246
    v_add_u32 v246, 12, v244
    v_xor_b32 v246, v246, v245
    v_lshlrev_b32 v246, 4, v246
    v_lshl_add_u32 v253, v244, 8, v246
    v_lshlrev_b32 v246, 2, v244
    v_xor_b32 v246, v246, v245
    v_lshlrev_b32 v246, 4, v246
    v_lshl_add_u32 v254, v244, 8, v246
    s_lshl_b32 s62, s3, 13
    s_add_u32 s63, s62, 32768
    s_mul_i32 s64, s2, 5
    s_mul_i32 s8, s3, 3
    s_add_u32 s64, s64, s8
    s_and_b32 s64, s64, 15
    s_lshl_b32 s64, s64, 13
    s_lshl_b32 s65, s3, 17
    s_add_u32 s66, s65, s64
    v_and_b32 v240, 3, v255
    v_add_u32 v240, s3, v240
    v_and_b32 v240, 3, v240
    v_and_b32 v241, 12, v255
    v_or_b32 v240, v240, v241
    v_lshlrev_b32 v240, 4, v240
    v_lshrrev_b32 v241, 4, v255
    v_lshlrev_b32 v242, 17, v241
    v_add_u32 v240, v240, v242
    v_lshrrev_b32 v242, 3, v255
    s_and_b32 s8, s67, 1
    v_xor_b32 v242, s8, v242
    v_lshlrev_b32 v242, 4, v242
    v_and_b32 v241, 7, v255
    v_lshl_add_u32 v242, v241, 10, v242
    v_add_u32 v243, 16384, v242
    s_lshr_b32 s8, s67, 1
    s_add_u32 s8, s8, 0
    s_and_b32 s8, s8, 1
    s_lshl_b32 s9, s3, 1
    s_add_u32 s8, s8, s9
    s_lshl_b32 s8, s8, 7
    s_add_u32 s9, s8, 8192
    buffer_load_dwordx4 v[128:131], v242, s[44:47], s8 offen
    buffer_load_dwordx4 v[136:139], v242, s[44:47], s9 offen
    buffer_load_dwordx4 v[132:135], v243, s[44:47], s8 offen
    buffer_load_dwordx4 v[140:143], v243, s[44:47], s9 offen
    s_lshr_b32 s8, s67, 1
    s_add_u32 s8, s8, 1
    s_and_b32 s8, s8, 1
    s_lshl_b32 s9, s3, 1
    s_add_u32 s8, s8, s9
    s_lshl_b32 s8, s8, 7
    s_add_u32 s9, s8, 8192
    buffer_load_dwordx4 v[144:147], v242, s[44:47], s8 offen
    buffer_load_dwordx4 v[152:155], v242, s[44:47], s9 offen
    buffer_load_dwordx4 v[148:151], v243, s[44:47], s8 offen
    buffer_load_dwordx4 v[156:159], v243, s[44:47], s9 offen
    s_lshr_b32 s8, s67, 1
    s_add_u32 s8, s8, 0
    s_and_b32 s8, s8, 1
    s_lshl_b32 s9, s3, 1
    s_add_u32 s8, s8, s9
    s_lshl_b32 s8, s8, 3
    s_add_u32 s9, s67, 0
    s_and_b32 s9, s9, 1
    s_add_u32 s8, s8, s9
    s_lshl_b32 s9, s8, 16
    buffer_load_dwordx4 v[0:3], v240, s[48:51], s9 offen
    s_add_u32 s11, s9, 8192
    buffer_load_dwordx4 v[4:7], v240, s[48:51], s11 offen
    s_add_u32 s10, s9, 16384
    buffer_load_dwordx4 v[8:11], v240, s[48:51], s10 offen
    s_add_u32 s11, s9, 24576
    buffer_load_dwordx4 v[12:15], v240, s[48:51], s11 offen
    s_add_u32 s10, s9, 32768
    buffer_load_dwordx4 v[16:19], v240, s[48:51], s10 offen
    s_add_u32 s11, s9, 40960
    buffer_load_dwordx4 v[20:23], v240, s[48:51], s11 offen
    s_add_u32 s10, s9, 49152
    buffer_load_dwordx4 v[24:27], v240, s[48:51], s10 offen
    s_add_u32 s11, s9, 57344
    buffer_load_dwordx4 v[28:31], v240, s[48:51], s11 offen
    s_lshr_b32 s8, s67, 1
    s_add_u32 s8, s8, 0
    s_and_b32 s8, s8, 1
    s_lshl_b32 s9, s3, 1
    s_add_u32 s8, s8, s9
    s_lshl_b32 s8, s8, 3
    s_add_u32 s9, s67, 1
    s_and_b32 s9, s9, 1
    s_add_u32 s8, s8, s9
    s_lshl_b32 s9, s8, 16
    buffer_load_dwordx4 v[32:35], v240, s[48:51], s9 offen
    s_add_u32 s11, s9, 8192
    buffer_load_dwordx4 v[36:39], v240, s[48:51], s11 offen
    s_add_u32 s10, s9, 16384
    buffer_load_dwordx4 v[40:43], v240, s[48:51], s10 offen
    s_add_u32 s11, s9, 24576
    buffer_load_dwordx4 v[44:47], v240, s[48:51], s11 offen
    s_add_u32 s10, s9, 32768
    buffer_load_dwordx4 v[48:51], v240, s[48:51], s10 offen
    s_add_u32 s11, s9, 40960
    buffer_load_dwordx4 v[52:55], v240, s[48:51], s11 offen
    s_add_u32 s10, s9, 49152
    buffer_load_dwordx4 v[56:59], v240, s[48:51], s10 offen
    s_add_u32 s11, s9, 57344
    buffer_load_dwordx4 v[60:63], v240, s[48:51], s11 offen
    s_lshr_b32 s8, s67, 1
    s_add_u32 s8, s8, 1
    s_and_b32 s8, s8, 1
    s_lshl_b32 s9, s3, 1
    s_add_u32 s8, s8, s9
    s_lshl_b32 s8, s8, 3
    s_add_u32 s9, s67, 0
    s_and_b32 s9, s9, 1
    s_add_u32 s8, s8, s9
    s_lshl_b32 s9, s8, 16
    buffer_load_dwordx4 v[64:67], v240, s[48:51], s9 offen
    s_add_u32 s11, s9, 8192
    buffer_load_dwordx4 v[68:71], v240, s[48:51], s11 offen
    s_add_u32 s10, s9, 16384
    buffer_load_dwordx4 v[72:75], v240, s[48:51], s10 offen
    s_add_u32 s11, s9, 24576
    buffer_load_dwordx4 v[76:79], v240, s[48:51], s11 offen
    s_add_u32 s10, s9, 32768
    buffer_load_dwordx4 v[80:83], v240, s[48:51], s10 offen
    s_add_u32 s11, s9, 40960
    buffer_load_dwordx4 v[84:87], v240, s[48:51], s11 offen
    s_add_u32 s10, s9, 49152
    buffer_load_dwordx4 v[88:91], v240, s[48:51], s10 offen
    s_add_u32 s11, s9, 57344
    buffer_load_dwordx4 v[92:95], v240, s[48:51], s11 offen
    s_lshr_b32 s8, s67, 1
    s_add_u32 s8, s8, 1
    s_and_b32 s8, s8, 1
    s_lshl_b32 s9, s3, 1
    s_add_u32 s8, s8, s9
    s_lshl_b32 s8, s8, 3
    s_add_u32 s9, s67, 1
    s_and_b32 s9, s9, 1
    s_add_u32 s8, s8, s9
    s_lshl_b32 s9, s8, 16
    buffer_load_dwordx4 v[96:99], v240, s[48:51], s9 offen
    s_add_u32 s11, s9, 8192
    buffer_load_dwordx4 v[100:103], v240, s[48:51], s11 offen
    s_add_u32 s10, s9, 16384
    buffer_load_dwordx4 v[104:107], v240, s[48:51], s10 offen
    s_add_u32 s11, s9, 24576
    buffer_load_dwordx4 v[108:111], v240, s[48:51], s11 offen
    s_add_u32 s10, s9, 32768
    buffer_load_dwordx4 v[112:115], v240, s[48:51], s10 offen
    s_add_u32 s11, s9, 40960
    buffer_load_dwordx4 v[116:119], v240, s[48:51], s11 offen
    s_add_u32 s10, s9, 49152
    buffer_load_dwordx4 v[120:123], v240, s[48:51], s10 offen
    s_add_u32 s11, s9, 57344
    buffer_load_dwordx4 v[124:127], v240, s[48:51], s11 offen
    s_mov_b32 m0, s62
    s_nop 0
    buffer_load_dwordx4 v250, s[52:55], s66 offen offset:0 nt lds
    buffer_load_dwordx4 v251, s[52:55], s66 offen offset:1024 nt lds
    buffer_load_dwordx4 v252, s[52:55], s66 offen offset:2048 nt lds
    buffer_load_dwordx4 v253, s[52:55], s66 offen offset:3072 nt lds
    s_add_u32 m0, s62, 4096
    s_add_u32 s78, s66, 4096
    buffer_load_dwordx4 v250, s[52:55], s78 offen offset:0 nt lds
    buffer_load_dwordx4 v251, s[52:55], s78 offen offset:1024 nt lds
    buffer_load_dwordx4 v252, s[52:55], s78 offen offset:2048 nt lds
    buffer_load_dwordx4 v253, s[52:55], s78 offen offset:3072 nt lds
    s_mov_b32 s78, 0x05040100
    s_mov_b32 s79, 0x07060302
    s_waitcnt vmcnt(32)
    v_mov_b32 v160, v128
    v_mov_b32 v161, v129
    v_mov_b32 v162, v130
    v_mov_b32 v163, v131
    v_mov_b32_dpp v128, v136 row_ror:8 row_mask:0xf bank_mask:0xc
    v_mov_b32_dpp v129, v137 row_ror:8 row_mask:0xf bank_mask:0xc
    v_mov_b32_dpp v130, v138 row_ror:8 row_mask:0xf bank_mask:0xc
    v_mov_b32_dpp v131, v139 row_ror:8 row_mask:0xf bank_mask:0xc
    v_mov_b32_dpp v136, v160 row_ror:8 row_mask:0xf bank_mask:0x3
    v_mov_b32_dpp v137, v161 row_ror:8 row_mask:0xf bank_mask:0x3
    v_mov_b32_dpp v138, v162 row_ror:8 row_mask:0xf bank_mask:0x3
    v_mov_b32_dpp v139, v163 row_ror:8 row_mask:0xf bank_mask:0x3
    v_mov_b32 v164, v132
    v_mov_b32 v165, v133
    v_mov_b32 v166, v134
    v_mov_b32 v167, v135
    v_mov_b32_dpp v132, v140 row_ror:8 row_mask:0xf bank_mask:0xc
    v_mov_b32_dpp v133, v141 row_ror:8 row_mask:0xf bank_mask:0xc
    v_mov_b32_dpp v134, v142 row_ror:8 row_mask:0xf bank_mask:0xc
    v_mov_b32_dpp v135, v143 row_ror:8 row_mask:0xf bank_mask:0xc
    v_mov_b32_dpp v140, v164 row_ror:8 row_mask:0xf bank_mask:0x3
    v_mov_b32_dpp v141, v165 row_ror:8 row_mask:0xf bank_mask:0x3
    v_mov_b32_dpp v142, v166 row_ror:8 row_mask:0xf bank_mask:0x3
    v_mov_b32_dpp v143, v167 row_ror:8 row_mask:0xf bank_mask:0x3
    v_perm_b32 v160, v4, v0, s78
    v_perm_b32 v164, v4, v0, s79
    v_perm_b32 v161, v12, v8, s78
    v_perm_b32 v165, v12, v8, s79
    v_perm_b32 v162, v20, v16, s78
    v_perm_b32 v166, v20, v16, s79
    v_perm_b32 v163, v28, v24, s78
    v_perm_b32 v167, v28, v24, s79
    s_nop 0
    v_mfma_f32_16x16x32_bf16 v[176:179], v[160:163], v[128:131], 0
    v_mfma_f32_16x16x32_bf16 v[180:183], v[160:163], v[132:135], 0
    v_mfma_f32_16x16x32_bf16 v[184:187], v[164:167], v[128:131], 0
    v_mfma_f32_16x16x32_bf16 v[188:191], v[164:167], v[132:135], 0
    v_perm_b32 v168, v5, v1, s78
    v_perm_b32 v172, v5, v1, s79
    v_perm_b32 v169, v13, v9, s78
    v_perm_b32 v173, v13, v9, s79
    v_perm_b32 v170, v21, v17, s78
    v_perm_b32 v174, v21, v17, s79
    v_perm_b32 v171, v29, v25, s78
    v_perm_b32 v175, v29, v25, s79
    s_nop 0
    v_mfma_f32_16x16x32_bf16 v[192:195], v[168:171], v[128:131], 0
    v_mfma_f32_16x16x32_bf16 v[196:199], v[168:171], v[132:135], 0
    v_mfma_f32_16x16x32_bf16 v[200:203], v[172:175], v[128:131], 0
    v_mfma_f32_16x16x32_bf16 v[204:207], v[172:175], v[132:135], 0
    v_perm_b32 v160, v6, v2, s78
    v_perm_b32 v164, v6, v2, s79
    v_perm_b32 v161, v14, v10, s78
    v_perm_b32 v165, v14, v10, s79
    v_perm_b32 v162, v22, v18, s78
    v_perm_b32 v166, v22, v18, s79
    v_perm_b32 v163, v30, v26, s78
    v_perm_b32 v167, v30, v26, s79
    s_nop 0
    v_mfma_f32_16x16x32_bf16 v[208:211], v[160:163], v[128:131], 0
    v_mfma_f32_16x16x32_bf16 v[212:215], v[160:163], v[132:135], 0
    v_mfma_f32_16x16x32_bf16 v[216:219], v[164:167], v[128:131], 0
    v_mfma_f32_16x16x32_bf16 v[220:223], v[164:167], v[132:135], 0
    v_perm_b32 v168, v7, v3, s78
    v_perm_b32 v172, v7, v3, s79
    v_perm_b32 v169, v15, v11, s78
    v_perm_b32 v173, v15, v11, s79
    v_perm_b32 v170, v23, v19, s78
    v_perm_b32 v174, v23, v19, s79
    v_perm_b32 v171, v31, v27, s78
    v_perm_b32 v175, v31, v27, s79
    s_nop 0
    v_mfma_f32_16x16x32_bf16 v[224:227], v[168:171], v[128:131], 0
    v_mfma_f32_16x16x32_bf16 v[228:231], v[168:171], v[132:135], 0
    v_mfma_f32_16x16x32_bf16 v[232:235], v[172:175], v[128:131], 0
    v_mfma_f32_16x16x32_bf16 v[236:239], v[172:175], v[132:135], 0
    s_waitcnt vmcnt(24)
    v_perm_b32 v160, v36, v32, s78
    v_perm_b32 v164, v36, v32, s79
    v_perm_b32 v161, v44, v40, s78
    v_perm_b32 v165, v44, v40, s79
    v_perm_b32 v162, v52, v48, s78
    v_perm_b32 v166, v52, v48, s79
    v_perm_b32 v163, v60, v56, s78
    v_perm_b32 v167, v60, v56, s79
    s_nop 0
    v_mfma_f32_16x16x32_bf16 v[176:179], v[160:163], v[136:139], v[176:179]
    v_mfma_f32_16x16x32_bf16 v[180:183], v[160:163], v[140:143], v[180:183]
    v_mfma_f32_16x16x32_bf16 v[184:187], v[164:167], v[136:139], v[184:187]
    v_mfma_f32_16x16x32_bf16 v[188:191], v[164:167], v[140:143], v[188:191]
    v_perm_b32 v168, v37, v33, s78
    v_perm_b32 v172, v37, v33, s79
    v_perm_b32 v169, v45, v41, s78
    v_perm_b32 v173, v45, v41, s79
    v_perm_b32 v170, v53, v49, s78
    v_perm_b32 v174, v53, v49, s79
    v_perm_b32 v171, v61, v57, s78
    v_perm_b32 v175, v61, v57, s79
    s_nop 0
    v_mfma_f32_16x16x32_bf16 v[192:195], v[168:171], v[136:139], v[192:195]
    v_mfma_f32_16x16x32_bf16 v[196:199], v[168:171], v[140:143], v[196:199]
    v_mfma_f32_16x16x32_bf16 v[200:203], v[172:175], v[136:139], v[200:203]
    v_mfma_f32_16x16x32_bf16 v[204:207], v[172:175], v[140:143], v[204:207]
    v_perm_b32 v160, v38, v34, s78
    v_perm_b32 v164, v38, v34, s79
    v_perm_b32 v161, v46, v42, s78
    v_perm_b32 v165, v46, v42, s79
    v_perm_b32 v162, v54, v50, s78
    v_perm_b32 v166, v54, v50, s79
    v_perm_b32 v163, v62, v58, s78
    v_perm_b32 v167, v62, v58, s79
    s_nop 0
    v_mfma_f32_16x16x32_bf16 v[208:211], v[160:163], v[136:139], v[208:211]
    v_mfma_f32_16x16x32_bf16 v[212:215], v[160:163], v[140:143], v[212:215]
    v_mfma_f32_16x16x32_bf16 v[216:219], v[164:167], v[136:139], v[216:219]
    v_mfma_f32_16x16x32_bf16 v[220:223], v[164:167], v[140:143], v[220:223]
    v_perm_b32 v168, v39, v35, s78
    v_perm_b32 v172, v39, v35, s79
    v_perm_b32 v169, v47, v43, s78
    v_perm_b32 v173, v47, v43, s79
    v_perm_b32 v170, v55, v51, s78
    v_perm_b32 v174, v55, v51, s79
    v_perm_b32 v171, v63, v59, s78
    v_perm_b32 v175, v63, v59, s79
    s_nop 0
    v_mfma_f32_16x16x32_bf16 v[224:227], v[168:171], v[136:139], v[224:227]
    v_mfma_f32_16x16x32_bf16 v[228:231], v[168:171], v[140:143], v[228:231]
    v_mfma_f32_16x16x32_bf16 v[232:235], v[172:175], v[136:139], v[232:235]
    v_mfma_f32_16x16x32_bf16 v[236:239], v[172:175], v[140:143], v[236:239]
    s_waitcnt vmcnt(16)
    v_mov_b32 v160, v144
    v_mov_b32 v161, v145
    v_mov_b32 v162, v146
    v_mov_b32 v163, v147
    v_mov_b32_dpp v144, v152 row_ror:8 row_mask:0xf bank_mask:0xc
    v_mov_b32_dpp v145, v153 row_ror:8 row_mask:0xf bank_mask:0xc
    v_mov_b32_dpp v146, v154 row_ror:8 row_mask:0xf bank_mask:0xc
    v_mov_b32_dpp v147, v155 row_ror:8 row_mask:0xf bank_mask:0xc
    v_mov_b32_dpp v152, v160 row_ror:8 row_mask:0xf bank_mask:0x3
    v_mov_b32_dpp v153, v161 row_ror:8 row_mask:0xf bank_mask:0x3
    v_mov_b32_dpp v154, v162 row_ror:8 row_mask:0xf bank_mask:0x3
    v_mov_b32_dpp v155, v163 row_ror:8 row_mask:0xf bank_mask:0x3
    v_mov_b32 v164, v148
    v_mov_b32 v165, v149
    v_mov_b32 v166, v150
    v_mov_b32 v167, v151
    v_mov_b32_dpp v148, v156 row_ror:8 row_mask:0xf bank_mask:0xc
    v_mov_b32_dpp v149, v157 row_ror:8 row_mask:0xf bank_mask:0xc
    v_mov_b32_dpp v150, v158 row_ror:8 row_mask:0xf bank_mask:0xc
    v_mov_b32_dpp v151, v159 row_ror:8 row_mask:0xf bank_mask:0xc
    v_mov_b32_dpp v156, v164 row_ror:8 row_mask:0xf bank_mask:0x3
    v_mov_b32_dpp v157, v165 row_ror:8 row_mask:0xf bank_mask:0x3
    v_mov_b32_dpp v158, v166 row_ror:8 row_mask:0xf bank_mask:0x3
    v_mov_b32_dpp v159, v167 row_ror:8 row_mask:0xf bank_mask:0x3
    v_perm_b32 v160, v68, v64, s78
    v_perm_b32 v164, v68, v64, s79
    v_perm_b32 v161, v76, v72, s78
    v_perm_b32 v165, v76, v72, s79
    v_perm_b32 v162, v84, v80, s78
    v_perm_b32 v166, v84, v80, s79
    v_perm_b32 v163, v92, v88, s78
    v_perm_b32 v167, v92, v88, s79
    s_nop 0
    v_mfma_f32_16x16x32_bf16 v[176:179], v[160:163], v[144:147], v[176:179]
    v_mfma_f32_16x16x32_bf16 v[180:183], v[160:163], v[148:151], v[180:183]
    v_mfma_f32_16x16x32_bf16 v[184:187], v[164:167], v[144:147], v[184:187]
    v_mfma_f32_16x16x32_bf16 v[188:191], v[164:167], v[148:151], v[188:191]
    v_perm_b32 v168, v69, v65, s78
    v_perm_b32 v172, v69, v65, s79
    v_perm_b32 v169, v77, v73, s78
    v_perm_b32 v173, v77, v73, s79
    v_perm_b32 v170, v85, v81, s78
    v_perm_b32 v174, v85, v81, s79
    v_perm_b32 v171, v93, v89, s78
    v_perm_b32 v175, v93, v89, s79
    s_nop 0
    v_mfma_f32_16x16x32_bf16 v[192:195], v[168:171], v[144:147], v[192:195]
    v_mfma_f32_16x16x32_bf16 v[196:199], v[168:171], v[148:151], v[196:199]
    v_mfma_f32_16x16x32_bf16 v[200:203], v[172:175], v[144:147], v[200:203]
    v_mfma_f32_16x16x32_bf16 v[204:207], v[172:175], v[148:151], v[204:207]
    v_perm_b32 v160, v70, v66, s78
    v_perm_b32 v164, v70, v66, s79
    v_perm_b32 v161, v78, v74, s78
    v_perm_b32 v165, v78, v74, s79
    v_perm_b32 v162, v86, v82, s78
    v_perm_b32 v166, v86, v82, s79
    v_perm_b32 v163, v94, v90, s78
    v_perm_b32 v167, v94, v90, s79
    s_nop 0
    v_mfma_f32_16x16x32_bf16 v[208:211], v[160:163], v[144:147], v[208:211]
    v_mfma_f32_16x16x32_bf16 v[212:215], v[160:163], v[148:151], v[212:215]
    v_mfma_f32_16x16x32_bf16 v[216:219], v[164:167], v[144:147], v[216:219]
    v_mfma_f32_16x16x32_bf16 v[220:223], v[164:167], v[148:151], v[220:223]
    v_perm_b32 v168, v71, v67, s78
    v_perm_b32 v172, v71, v67, s79
    v_perm_b32 v169, v79, v75, s78
    v_perm_b32 v173, v79, v75, s79
    v_perm_b32 v170, v87, v83, s78
    v_perm_b32 v174, v87, v83, s79
    v_perm_b32 v171, v95, v91, s78
    v_perm_b32 v175, v95, v91, s79
    s_nop 0
    v_mfma_f32_16x16x32_bf16 v[224:227], v[168:171], v[144:147], v[224:227]
    v_mfma_f32_16x16x32_bf16 v[228:231], v[168:171], v[148:151], v[228:231]
    v_mfma_f32_16x16x32_bf16 v[232:235], v[172:175], v[144:147], v[232:235]
    v_mfma_f32_16x16x32_bf16 v[236:239], v[172:175], v[148:151], v[236:239]
    s_waitcnt vmcnt(8)
    v_perm_b32 v160, v100, v96, s78
    v_perm_b32 v164, v100, v96, s79
    v_perm_b32 v161, v108, v104, s78
    v_perm_b32 v165, v108, v104, s79
    v_perm_b32 v162, v116, v112, s78
    v_perm_b32 v166, v116, v112, s79
    v_perm_b32 v163, v124, v120, s78
    v_perm_b32 v167, v124, v120, s79
    s_nop 0
    v_mfma_f32_16x16x32_bf16 v[176:179], v[160:163], v[152:155], v[176:179]
    v_mfma_f32_16x16x32_bf16 v[180:183], v[160:163], v[156:159], v[180:183]
    v_mfma_f32_16x16x32_bf16 v[184:187], v[164:167], v[152:155], v[184:187]
    v_mfma_f32_16x16x32_bf16 v[188:191], v[164:167], v[156:159], v[188:191]
    v_perm_b32 v168, v101, v97, s78
    v_perm_b32 v172, v101, v97, s79
    v_perm_b32 v169, v109, v105, s78
    v_perm_b32 v173, v109, v105, s79
    v_perm_b32 v170, v117, v113, s78
    v_perm_b32 v174, v117, v113, s79
    v_perm_b32 v171, v125, v121, s78
    v_perm_b32 v175, v125, v121, s79
    s_nop 0
    v_mfma_f32_16x16x32_bf16 v[192:195], v[168:171], v[152:155], v[192:195]
    v_mfma_f32_16x16x32_bf16 v[196:199], v[168:171], v[156:159], v[196:199]
    v_mfma_f32_16x16x32_bf16 v[200:203], v[172:175], v[152:155], v[200:203]
    v_mfma_f32_16x16x32_bf16 v[204:207], v[172:175], v[156:159], v[204:207]
    v_perm_b32 v160, v102, v98, s78
    v_perm_b32 v164, v102, v98, s79
    v_perm_b32 v161, v110, v106, s78
    v_perm_b32 v165, v110, v106, s79
    v_perm_b32 v162, v118, v114, s78
    v_perm_b32 v166, v118, v114, s79
    v_perm_b32 v163, v126, v122, s78
    v_perm_b32 v167, v126, v122, s79
    s_nop 0
    v_mfma_f32_16x16x32_bf16 v[208:211], v[160:163], v[152:155], v[208:211]
    v_mfma_f32_16x16x32_bf16 v[212:215], v[160:163], v[156:159], v[212:215]
    v_mfma_f32_16x16x32_bf16 v[216:219], v[164:167], v[152:155], v[216:219]
    v_mfma_f32_16x16x32_bf16 v[220:223], v[164:167], v[156:159], v[220:223]
    v_perm_b32 v168, v103, v99, s78
    v_perm_b32 v172, v103, v99, s79
    v_perm_b32 v169, v111, v107, s78
    v_perm_b32 v173, v111, v107, s79
    v_perm_b32 v170, v119, v115, s78
    v_perm_b32 v174, v119, v115, s79
    v_perm_b32 v171, v127, v123, s78
    v_perm_b32 v175, v127, v123, s79
    s_nop 0
    v_mfma_f32_16x16x32_bf16 v[224:227], v[168:171], v[152:155], v[224:227]
    v_mfma_f32_16x16x32_bf16 v[228:231], v[168:171], v[156:159], v[228:231]
    v_mfma_f32_16x16x32_bf16 v[232:235], v[172:175], v[152:155], v[232:235]
    v_mfma_f32_16x16x32_bf16 v[236:239], v[172:175], v[156:159], v[236:239]
    s_mov_b32 m0, s63
    s_nop 0
    buffer_load_dwordx4 v254, s[56:59], s66 offen offset:0 nt lds
    buffer_load_dwordx4 v254, s[56:59], s66 offen offset:1024 nt lds
    buffer_load_dwordx4 v254, s[56:59], s66 offen offset:2048 nt lds
    buffer_load_dwordx4 v254, s[56:59], s66 offen offset:3072 nt lds
    s_add_u32 m0, s63, 4096
    s_add_u32 s80, s66, 4096
    buffer_load_dwordx4 v254, s[56:59], s80 offen offset:0 nt lds
    buffer_load_dwordx4 v254, s[56:59], s80 offen offset:1024 nt lds
    buffer_load_dwordx4 v254, s[56:59], s80 offen offset:2048 nt lds
    buffer_load_dwordx4 v254, s[56:59], s80 offen offset:3072 nt lds
    v_mov_b32 v0, v177
    v_mov_b32 v1, v185
    v_mov_b32 v2, v193
    v_mov_b32 v3, v201
    v_mov_b32 v4, v209
    v_mov_b32 v5, v217
    v_mov_b32 v6, v225
    v_mov_b32 v7, v233
    v_mov_b32 v8, v181
    v_mov_b32 v9, v189
    v_mov_b32 v10, v197
    v_mov_b32 v11, v205
    v_mov_b32 v12, v213
    v_mov_b32 v13, v221
    v_mov_b32 v14, v229
    v_mov_b32 v15, v237
    v_mov_b32 v16, v178
    v_mov_b32 v17, v186
    v_mov_b32 v18, v194
    v_mov_b32 v19, v202
    v_mov_b32 v20, v210
    v_mov_b32 v21, v218
    v_mov_b32 v22, v226
    v_mov_b32 v23, v234
    v_mov_b32 v24, v182
    v_mov_b32 v25, v190
    v_mov_b32 v26, v198
    v_mov_b32 v27, v206
    v_mov_b32 v28, v214
    v_mov_b32 v29, v222
    v_mov_b32 v30, v230
    v_mov_b32 v31, v238
    v_mov_b32 v32, v179
    v_mov_b32 v33, v187
    v_mov_b32 v34, v195
    v_mov_b32 v35, v203
    v_mov_b32 v36, v211
    v_mov_b32 v37, v219
    v_mov_b32 v38, v227
    v_mov_b32 v39, v235
    v_mov_b32 v40, v183
    v_mov_b32 v41, v191
    v_mov_b32 v42, v199
    v_mov_b32 v43, v207
    v_mov_b32 v44, v215
    v_mov_b32 v45, v223
    v_mov_b32 v46, v231
    v_mov_b32 v47, v239
    v_lshlrev_b32 v245, 4, v255
    s_lshl_b32 s12, s3, 12
    s_add_u32 s12, s12, 65536
    v_add_u32 v246, s12, v245
    s_add_u32 s12, s3, 1
    s_and_b32 s12, s12, 3
    s_lshl_b32 s12, s12, 12
    s_add_u32 s12, s12, 65536
    v_add_u32 v244, s12, v245
    ds_write_b128 v244, v[0:3] offset:0
    ds_write_b128 v244, v[4:7] offset:1024
    ds_write_b128 v244, v[8:11] offset:2048
    ds_write_b128 v244, v[12:15] offset:3072
    s_waitcnt lgkmcnt(0)
    s_barrier
    ds_read_b128 v[48:51], v246 offset:0
    ds_read_b128 v[52:55], v246 offset:1024
    ds_read_b128 v[56:59], v246 offset:2048
    ds_read_b128 v[60:63], v246 offset:3072
    s_waitcnt lgkmcnt(0)
    s_add_u32 s12, s3, 2
    s_and_b32 s12, s12, 3
    s_lshl_b32 s12, s12, 12
    s_add_u32 s12, s12, 65536
    v_add_u32 v244, s12, v245
    s_barrier
    ds_write_b128 v244, v[16:19] offset:0
    ds_write_b128 v244, v[20:23] offset:1024
    ds_write_b128 v244, v[24:27] offset:2048
    ds_write_b128 v244, v[28:31] offset:3072
    v_add_f32 v176, v176, v48
    v_add_f32 v184, v184, v49
    v_add_f32 v192, v192, v50
    v_add_f32 v200, v200, v51
    v_add_f32 v208, v208, v52
    v_add_f32 v216, v216, v53
    v_add_f32 v224, v224, v54
    v_add_f32 v232, v232, v55
    v_add_f32 v180, v180, v56
    v_add_f32 v188, v188, v57
    v_add_f32 v196, v196, v58
    v_add_f32 v204, v204, v59
    v_add_f32 v212, v212, v60
    v_add_f32 v220, v220, v61
    v_add_f32 v228, v228, v62
    v_add_f32 v236, v236, v63
    s_waitcnt lgkmcnt(0)
    s_barrier
    ds_read_b128 v[64:67], v246 offset:0
    ds_read_b128 v[68:71], v246 offset:1024
    ds_read_b128 v[72:75], v246 offset:2048
    ds_read_b128 v[76:79], v246 offset:3072
    s_waitcnt lgkmcnt(0)
    s_add_u32 s12, s3, 3
    s_and_b32 s12, s12, 3
    s_lshl_b32 s12, s12, 12
    s_add_u32 s12, s12, 65536
    v_add_u32 v244, s12, v245
    s_barrier
    ds_write_b128 v244, v[32:35] offset:0
    ds_write_b128 v244, v[36:39] offset:1024
    ds_write_b128 v244, v[40:43] offset:2048
    ds_write_b128 v244, v[44:47] offset:3072
    v_add_f32 v176, v176, v64
    v_add_f32 v184, v184, v65
    v_add_f32 v192, v192, v66
    v_add_f32 v200, v200, v67
    v_add_f32 v208, v208, v68
    v_add_f32 v216, v216, v69
    v_add_f32 v224, v224, v70
    v_add_f32 v232, v232, v71
    v_add_f32 v180, v180, v72
    v_add_f32 v188, v188, v73
    v_add_f32 v196, v196, v74
    v_add_f32 v204, v204, v75
    v_add_f32 v212, v212, v76
    v_add_f32 v220, v220, v77
    v_add_f32 v228, v228, v78
    v_add_f32 v236, v236, v79
    s_waitcnt lgkmcnt(0)
    s_barrier
    ds_read_b128 v[80:83], v246 offset:0
    ds_read_b128 v[84:87], v246 offset:1024
    ds_read_b128 v[88:91], v246 offset:2048
    ds_read_b128 v[92:95], v246 offset:3072
    s_waitcnt lgkmcnt(0)
    v_add_f32 v176, v176, v80
    v_add_f32 v184, v184, v81
    v_add_f32 v192, v192, v82
    v_add_f32 v200, v200, v83
    v_add_f32 v208, v208, v84
    v_add_f32 v216, v216, v85
    v_add_f32 v224, v224, v86
    v_add_f32 v232, v232, v87
    v_add_f32 v180, v180, v88
    v_add_f32 v188, v188, v89
    v_add_f32 v196, v196, v90
    v_add_f32 v204, v204, v91
    v_add_f32 v212, v212, v92
    v_add_f32 v220, v220, v93
    v_add_f32 v228, v228, v94
    v_add_f32 v236, v236, v95
    v_cvt_pk_bf16_f32 v16, v176, v184
    v_cvt_pk_bf16_f32 v17, v192, v200
    v_cvt_pk_bf16_f32 v18, v208, v216
    v_cvt_pk_bf16_f32 v19, v224, v232
    v_cvt_pk_bf16_f32 v20, v180, v188
    v_cvt_pk_bf16_f32 v21, v196, v204
    v_cvt_pk_bf16_f32 v22, v212, v220
    v_cvt_pk_bf16_f32 v23, v228, v236
    s_barrier
    v_lshrrev_b32 v224, 4, v255
    v_lshlrev_b32 v224, 11, v224
    v_and_b32 v225, 15, v255
    v_lshl_add_u32 v224, v225, 4, v224
    s_lshl_b32 s8, s3, 9
    s_add_u32 s8, s8, 65536
    v_add_u32 v224, s8, v224
    ds_write_b128 v224, v[16:19]
    ds_write_b128 v224, v[20:23] offset:256
    s_mov_b32 s79, s62
    s_mov_b32 s80, s63
    s_mov_b32 s81, s3
    s_call_b64 s[96:97], SUB_READS
    s_waitcnt lgkmcnt(0)
    s_barrier
    v_lshrrev_b32 v216, 5, v255
    v_lshlrev_b32 v216, 12, v216
    v_and_b32 v217, 31, v255
    v_lshl_add_u32 v216, v217, 4, v216
    v_add_u32 v216, 65536, v216
    ds_read_b128 v[0:3], v216 offset:0
    ds_read_b128 v[4:7], v216 offset:512
    ds_read_b128 v[8:11], v216 offset:1024
    ds_read_b128 v[12:15], v216 offset:1536
    ds_read_b128 v[16:19], v216 offset:2048
    ds_read_b128 v[20:23], v216 offset:2560
    ds_read_b128 v[24:27], v216 offset:3072
    ds_read_b128 v[28:31], v216 offset:3584
    s_mov_b32 s93, 1
    s_mov_b32 s16, s40
    s_mov_b32 s17, s41
    s_and_b32 s17, s17, 0xffff
    s_mov_b32 s18, 131072
    s_mov_b32 s19, 0x20000
    s_mov_b32 s61, 0
    v_mov_b32 v132, 0
    s_setprio 0
B_loop:
    s_waitcnt vmcnt(0)
    s_cmp_eq_u32 s61, 0
    s_cbranch_scc1 L_v0_1
    s_mov_b32 m0, s63
    s_nop 0
    buffer_load_dwordx4 v254, s[56:59], s66 offen offset:0 nt lds
    buffer_load_dwordx4 v254, s[56:59], s66 offen offset:1024 nt lds
    buffer_load_dwordx4 v254, s[56:59], s66 offen offset:2048 nt lds
    buffer_load_dwordx4 v254, s[56:59], s66 offen offset:3072 nt lds
    s_add_u32 m0, s63, 4096
    s_add_u32 s78, s66, 4096
    buffer_load_dwordx4 v254, s[56:59], s78 offen offset:0 nt lds
    buffer_load_dwordx4 v254, s[56:59], s78 offen offset:1024 nt lds
    buffer_load_dwordx4 v254, s[56:59], s78 offen offset:2048 nt lds
    buffer_load_dwordx4 v254, s[56:59], s78 offen offset:3072 nt lds
L_v0_1:
    ds_read_b128 v[96:99], v234
    ds_read_b128 v[100:103], v235
    ds_read_b128 v[104:107], v236
    ds_read_b128 v[108:111], v237
    ds_read_b128 v[112:115], v238
    ds_read_b128 v[116:119], v239
    ds_read_b128 v[120:123], v240
    ds_read_b128 v[124:127], v241
    s_add_u32 s64, s64, 8192
    s_and_b32 s64, s64, 0x1ffff
    s_add_u32 s66, s65, s64
    s_waitcnt lgkmcnt(0)
    v_mfma_f32_32x32x16_bf16 v[192:207], v[96:99], v[0:3], 0
    v_mfma_f32_32x32x16_bf16 v[192:207], v[100:103], v[4:7], v[192:207]
    v_mfma_f32_32x32x16_bf16 v[192:207], v[104:107], v[8:11], v[192:207]
    v_mfma_f32_32x32x16_bf16 v[192:207], v[108:111], v[12:15], v[192:207]
    v_mfma_f32_32x32x16_bf16 v[192:207], v[112:115], v[16:19], v[192:207]
    v_mfma_f32_32x32x16_bf16 v[192:207], v[116:119], v[20:23], v[192:207]
    v_mfma_f32_32x32x16_bf16 v[192:207], v[120:123], v[24:27], v[192:207]
    v_mfma_f32_32x32x16_bf16 v[192:207], v[124:127], v[28:31], v[192:207]
    s_call_b64 s[96:97], SUB_SOFT2
    s_waitcnt vmcnt(0)
    s_cmp_eq_u32 s61, 4
    s_cbranch_scc0 L_nic_2
    global_load_dword v128, v132, s[38:39] sc1
L_nic_2:
    s_cmp_eq_u32 s61, 15
    s_cbranch_scc0 L_knext_3
    s_add_u32 m0, s89, 0
    s_add_u32 s78, s88, 0
    buffer_load_dwordx4 v246, s[48:51], s78 offen  lds
    s_add_u32 m0, s89, 1024
    s_add_u32 s79, s88, 8192
    buffer_load_dwordx4 v246, s[48:51], s79 offen  lds
    s_add_u32 m0, s89, 2048
    s_add_u32 s78, s88, 16384
    buffer_load_dwordx4 v246, s[48:51], s78 offen  lds
    s_add_u32 m0, s89, 3072
    s_add_u32 s79, s88, 24576
    buffer_load_dwordx4 v246, s[48:51], s79 offen  lds
    s_add_u32 m0, s89, 4096
    s_add_u32 s78, s88, 32768
    buffer_load_dwordx4 v246, s[48:51], s78 offen  lds
    s_add_u32 m0, s89, 5120
    s_add_u32 s79, s88, 40960
    buffer_load_dwordx4 v246, s[48:51], s79 offen  lds
    s_add_u32 m0, s89, 6144
    s_add_u32 s78, s88, 49152
    buffer_load_dwordx4 v246, s[48:51], s78 offen  lds
    s_branch L_kdone_4
L_knext_3:
    s_mov_b32 m0, s62
    s_nop 0
    buffer_load_dwordx4 v250, s[52:55], s66 offen offset:0 nt lds
    buffer_load_dwordx4 v251, s[52:55], s66 offen offset:1024 nt lds
    buffer_load_dwordx4 v252, s[52:55], s66 offen offset:2048 nt lds
    buffer_load_dwordx4 v253, s[52:55], s66 offen offset:3072 nt lds
    s_add_u32 m0, s62, 4096
    s_add_u32 s78, s66, 4096
    buffer_load_dwordx4 v250, s[52:55], s78 offen offset:0 nt lds
    buffer_load_dwordx4 v251, s[52:55], s78 offen offset:1024 nt lds
    buffer_load_dwordx4 v252, s[52:55], s78 offen offset:2048 nt lds
    buffer_load_dwordx4 v253, s[52:55], s78 offen offset:3072 nt lds
L_kdone_4:
    s_cmp_eq_u32 s61, 1
    s_cbranch_scc0 L_nts_5
    s_call_b64 s[96:97], TAIL_SETUP
L_nts_5:
    s_cmp_eq_u32 s61, 12
    s_cbranch_scc0 L_nnc_6
    s_mov_b32 s90, 400000
L_ichk_7:
    v_readfirstlane_b32 s91, v128
    s_cmp_lg_u32 s91, 0
    s_cbranch_scc1 L_iok_8
    s_sleep 1
    global_load_dword v128, v132, s[38:39] sc1
    s_waitcnt vmcnt(0)
    s_sub_u32 s90, s90, 1
    s_cmp_lg_u32 s90, 0
    s_cbranch_scc1 L_ichk_7
L_iok_8:
    v_mov_b32 v148, s91
L_nnc_6:
    ds_read_b64_tr_b16 v[96:97], v242 offset:0
    ds_read_b64_tr_b16 v[98:99], v242 offset:2048
    ds_read_b64_tr_b16 v[104:105], v243 offset:0
    ds_read_b64_tr_b16 v[106:107], v243 offset:2048
    ds_read_b64_tr_b16 v[112:113], v244 offset:0
    ds_read_b64_tr_b16 v[114:115], v244 offset:2048
    ds_read_b64_tr_b16 v[120:121], v245 offset:0
    ds_read_b64_tr_b16 v[122:123], v245 offset:2048
    ds_read_b64_tr_b16 v[100:101], v242 offset:4096
    ds_read_b64_tr_b16 v[102:103], v242 offset:6144
    ds_read_b64_tr_b16 v[108:109], v243 offset:4096
    ds_read_b64_tr_b16 v[110:111], v243 offset:6144
    ds_read_b64_tr_b16 v[116:117], v244 offset:4096
    ds_read_b64_tr_b16 v[118:119], v244 offset:6144
    ds_read_b64_tr_b16 v[124:125], v245 offset:4096
    ds_read_b64_tr_b16 v[126:127], v245 offset:6144
    s_waitcnt lgkmcnt(0)
    v_mfma_f32_32x32x16_bf16 v[32:47], v[96:99], v[208:211], v[32:47]
    v_mfma_f32_32x32x16_bf16 v[48:63], v[104:107], v[208:211], v[48:63]
    v_mfma_f32_32x32x16_bf16 v[64:79], v[112:115], v[208:211], v[64:79]
    v_mfma_f32_32x32x16_bf16 v[80:95], v[120:123], v[208:211], v[80:95]
    v_mfma_f32_32x32x16_bf16 v[32:47], v[100:103], v[212:215], v[32:47]
    v_mfma_f32_32x32x16_bf16 v[48:63], v[108:111], v[212:215], v[48:63]
    v_mfma_f32_32x32x16_bf16 v[64:79], v[116:119], v[212:215], v[64:79]
    v_mfma_f32_32x32x16_bf16 v[80:95], v[124:127], v[212:215], v[80:95]
    s_add_u32 s61, s61, 1
    s_cmp_lt_u32 s61, 16
    s_cbranch_scc1 B_loop
    s_setprio 3
    global_load_dword v240, v230, s[40:41] sc1
    global_load_dword v241, v231, s[40:41] sc1
    s_nop 3
    ds_write_b128 v137, v[48:51] offset:0
    ds_write_b128 v137, v[52:55] offset:1024
    ds_write_b128 v137, v[56:59] offset:2048
    ds_write_b128 v137, v[60:63] offset:3072
    ds_write_b128 v137, v[64:67] offset:4096
    ds_write_b128 v137, v[68:71] offset:5120
    ds_write_b128 v137, v[72:75] offset:6144
    ds_write_b128 v137, v[76:79] offset:7168
    ds_write_b128 v138, v[80:83] offset:0
    ds_write_b128 v138, v[84:87] offset:1024
    ds_write_b128 v138, v[88:91] offset:2048
    ds_write_b128 v138, v[92:95] offset:3072
    v_mov_b32 v216, v233
    s_nop 1
    v_permlane32_swap_b32 v233, v216
    v_add_f32 v233, v233, v216
    v_cndmask_b32 v216, v232, v233, s[20:21]
    ds_write_b32 v136, v216
    s_waitcnt lgkmcnt(0)
    s_barrier
    ds_read2_b32 v[218:219], v139 offset0:0 offset1:32
    ds_read2_b32 v[220:221], v140 offset0:0 offset1:32
    ds_read2_b32 v[222:223], v141 offset0:0 offset1:32
    ds_read2_b32 v[224:225], v142 offset0:0 offset1:32
    ds_read_b128 v[0:3], v143 offset:0
    ds_read_b128 v[4:7], v143 offset:1024
    ds_read_b128 v[8:11], v143 offset:2048
    ds_read_b128 v[12:15], v143 offset:3072
    ds_read_b128 v[16:19], v144 offset:0
    ds_read_b128 v[20:23], v144 offset:1024
    ds_read_b128 v[24:27], v144 offset:2048
    ds_read_b128 v[28:31], v144 offset:3072
    ds_read_b128 v[96:99], v145 offset:0
    ds_read_b128 v[100:103], v145 offset:1024
    ds_read_b128 v[104:107], v145 offset:2048
    ds_read_b128 v[108:111], v145 offset:3072
    s_waitcnt lgkmcnt(12)
    v_max3_f32 v216, v218, v220, v222
    v_max_f32 v216, v216, v224
    v_sub_f32 v218, v218, v216
    v_sub_f32 v220, v220, v216
    v_sub_f32 v222, v222, v216
    v_sub_f32 v224, v224, v216
    v_mul_f32 v218, s60, v218
    v_mul_f32 v220, s60, v220
    v_mul_f32 v222, s60, v222
    v_mul_f32 v224, s60, v224
    v_exp_f32 v218, v218
    v_exp_f32 v220, v220
    v_exp_f32 v222, v222
    v_exp_f32 v224, v224
    v_mul_f32 v216, v218, v219
    v_fma_f32 v216, v220, v221, v216
    v_fma_f32 v216, v222, v223, v216
    v_fma_f32 v216, v224, v225, v216
    v_rcp_f32 v216, v216
    s_nop 0
    v_mul_f32 v218, v218, v216
    v_mul_f32 v220, v220, v216
    v_mul_f32 v222, v222, v216
    v_mul_f32 v224, v224, v216
    v_pk_mul_f32 v[32:33], v[32:33], v[218:219] op_sel_hi:[1,0]
    v_pk_mul_f32 v[34:35], v[34:35], v[218:219] op_sel_hi:[1,0]
    v_pk_mul_f32 v[36:37], v[36:37], v[218:219] op_sel_hi:[1,0]
    v_pk_mul_f32 v[38:39], v[38:39], v[218:219] op_sel_hi:[1,0]
    v_pk_mul_f32 v[40:41], v[40:41], v[218:219] op_sel_hi:[1,0]
    v_pk_mul_f32 v[42:43], v[42:43], v[218:219] op_sel_hi:[1,0]
    v_pk_mul_f32 v[44:45], v[44:45], v[218:219] op_sel_hi:[1,0]
    v_pk_mul_f32 v[46:47], v[46:47], v[218:219] op_sel_hi:[1,0]
    s_waitcnt lgkmcnt(8)
    v_pk_fma_f32 v[32:33], v[0:1], v[220:221], v[32:33] op_sel_hi:[1,0,1]
    v_pk_fma_f32 v[34:35], v[2:3], v[220:221], v[34:35] op_sel_hi:[1,0,1]
    v_pk_fma_f32 v[36:37], v[4:5], v[220:221], v[36:37] op_sel_hi:[1,0,1]
    v_pk_fma_f32 v[38:39], v[6:7], v[220:221], v[38:39] op_sel_hi:[1,0,1]
    v_pk_fma_f32 v[40:41], v[8:9], v[220:221], v[40:41] op_sel_hi:[1,0,1]
    v_pk_fma_f32 v[42:43], v[10:11], v[220:221], v[42:43] op_sel_hi:[1,0,1]
    v_pk_fma_f32 v[44:45], v[12:13], v[220:221], v[44:45] op_sel_hi:[1,0,1]
    v_pk_fma_f32 v[46:47], v[14:15], v[220:221], v[46:47] op_sel_hi:[1,0,1]
    s_waitcnt lgkmcnt(4)
    v_pk_fma_f32 v[32:33], v[16:17], v[222:223], v[32:33] op_sel_hi:[1,0,1]
    v_pk_fma_f32 v[34:35], v[18:19], v[222:223], v[34:35] op_sel_hi:[1,0,1]
    v_pk_fma_f32 v[36:37], v[20:21], v[222:223], v[36:37] op_sel_hi:[1,0,1]
    v_pk_fma_f32 v[38:39], v[22:23], v[222:223], v[38:39] op_sel_hi:[1,0,1]
    v_pk_fma_f32 v[40:41], v[24:25], v[222:223], v[40:41] op_sel_hi:[1,0,1]
    v_pk_fma_f32 v[42:43], v[26:27], v[222:223], v[42:43] op_sel_hi:[1,0,1]
    v_pk_fma_f32 v[44:45], v[28:29], v[222:223], v[44:45] op_sel_hi:[1,0,1]
    v_pk_fma_f32 v[46:47], v[30:31], v[222:223], v[46:47] op_sel_hi:[1,0,1]
    s_waitcnt lgkmcnt(0)
    v_pk_fma_f32 v[32:33], v[96:97], v[224:225], v[32:33] op_sel_hi:[1,0,1]
    v_pk_fma_f32 v[34:35], v[98:99], v[224:225], v[34:35] op_sel_hi:[1,0,1]
    v_pk_fma_f32 v[36:37], v[100:101], v[224:225], v[36:37] op_sel_hi:[1,0,1]
    v_pk_fma_f32 v[38:39], v[102:103], v[224:225], v[38:39] op_sel_hi:[1,0,1]
    v_pk_fma_f32 v[40:41], v[104:105], v[224:225], v[40:41] op_sel_hi:[1,0,1]
    v_pk_fma_f32 v[42:43], v[106:107], v[224:225], v[42:43] op_sel_hi:[1,0,1]
    v_pk_fma_f32 v[44:45], v[108:109], v[224:225], v[44:45] op_sel_hi:[1,0,1]
    v_pk_fma_f32 v[46:47], v[110:111], v[224:225], v[46:47] op_sel_hi:[1,0,1]
    v_cvt_pk_bf16_f32 v208, v32, v33
    v_cvt_pk_bf16_f32 v209, v34, v35
    v_cvt_pk_bf16_f32 v210, v36, v37
    v_cvt_pk_bf16_f32 v211, v38, v39
    v_cvt_pk_bf16_f32 v212, v40, v41
    v_cvt_pk_bf16_f32 v213, v42, v43
    v_cvt_pk_bf16_f32 v214, v44, v45
    v_cvt_pk_bf16_f32 v215, v46, v47
    s_waitcnt vmcnt(0)
    global_store_dwordx4 v146, v[208:211], s[70:71] sc1
    global_store_dwordx4 v146, v[212:215], s[70:71] offset:1024 sc1
    s_branch L_EPI2
SUB_READS:
    v_and_b32 v216, 31, v255
    v_lshrrev_b32 v217, 5, v255
    v_and_b32 v218, 15, v255
    v_lshlrev_b32 v219, 3, v217
    v_xor_b32 v218, v218, v219
    v_lshlrev_b32 v218, 4, v218
    v_lshl_add_u32 v218, v216, 8, v218
    v_xor_b32 v234, 0, v218
    v_add_u32 v234, s79, v234
    v_xor_b32 v235, 16, v218
    v_add_u32 v235, s79, v235
    v_xor_b32 v236, 32, v218
    v_add_u32 v236, s79, v236
    v_xor_b32 v237, 48, v218
    v_add_u32 v237, s79, v237
    v_xor_b32 v238, 64, v218
    v_add_u32 v238, s79, v238
    v_xor_b32 v239, 80, v218
    v_add_u32 v239, s79, v239
    v_xor_b32 v240, 96, v218
    v_add_u32 v240, s79, v240
    v_xor_b32 v241, 112, v218
    v_add_u32 v241, s79, v241
    v_and_b32 v216, 15, v255
    v_lshrrev_b32 v218, 2, v216
    v_and_b32 v219, 3, v216
    v_lshl_add_u32 v220, v217, 2, v218
    v_lshlrev_b32 v220, 8, v220
    v_bfe_u32 v221, v255, 4, 1
    v_lshlrev_b32 v221, 1, v221
    v_lshrrev_b32 v222, 1, v219
    v_add_u32 v221, v221, v222
    v_lshlrev_b32 v222, 2, v218
    v_xor_b32 v221, v221, v222
    v_lshl_add_u32 v220, v221, 4, v220
    v_and_b32 v219, 1, v219
    v_lshl_add_u32 v220, v219, 3, v220
    s_add_u32 s8, s81, 0
    s_and_b32 s8, s8, 3
    s_lshl_b32 s8, s8, 6
    v_xor_b32 v242, s8, v220
    v_add_u32 v242, s80, v242
    s_add_u32 s8, s81, 1
    s_and_b32 s8, s8, 3
    s_lshl_b32 s8, s8, 6
    v_xor_b32 v243, s8, v220
    v_add_u32 v243, s80, v243
    s_add_u32 s8, s81, 2
    s_and_b32 s8, s8, 3
    s_lshl_b32 s8, s8, 6
    v_xor_b32 v244, s8, v220
    v_add_u32 v244, s80, v244
    s_add_u32 s8, s81, 3
    s_and_b32 s8, s8, 3
    s_lshl_b32 s8, s8, 6
    v_xor_b32 v245, s8, v220
    v_add_u32 v245, s80, v245
    v_mov_b32 v32, 0
    v_mov_b32 v33, 0
    v_mov_b32 v34, 0
    v_mov_b32 v35, 0
    v_mov_b32 v36, 0
    v_mov_b32 v37, 0
    v_mov_b32 v38, 0
    v_mov_b32 v39, 0
    v_mov_b32 v40, 0
    v_mov_b32 v41, 0
    v_mov_b32 v42, 0
    v_mov_b32 v43, 0
    v_mov_b32 v44, 0
    v_mov_b32 v45, 0
    v_mov_b32 v46, 0
    v_mov_b32 v47, 0
    v_mov_b32 v48, 0
    v_mov_b32 v49, 0
    v_mov_b32 v50, 0
    v_mov_b32 v51, 0
    v_mov_b32 v52, 0
    v_mov_b32 v53, 0
    v_mov_b32 v54, 0
    v_mov_b32 v55, 0
    v_mov_b32 v56, 0
    v_mov_b32 v57, 0
    v_mov_b32 v58, 0
    v_mov_b32 v59, 0
    v_mov_b32 v60, 0
    v_mov_b32 v61, 0
    v_mov_b32 v62, 0
    v_mov_b32 v63, 0
    v_mov_b32 v64, 0
    v_mov_b32 v65, 0
    v_mov_b32 v66, 0
    v_mov_b32 v67, 0
    v_mov_b32 v68, 0
    v_mov_b32 v69, 0
    v_mov_b32 v70, 0
    v_mov_b32 v71, 0
    v_mov_b32 v72, 0
    v_mov_b32 v73, 0
    v_mov_b32 v74, 0
    v_mov_b32 v75, 0
    v_mov_b32 v76, 0
    v_mov_b32 v77, 0
    v_mov_b32 v78, 0
    v_mov_b32 v79, 0
    v_mov_b32 v80, 0
    v_mov_b32 v81, 0
    v_mov_b32 v82, 0
    v_mov_b32 v83, 0
    v_mov_b32 v84, 0
    v_mov_b32 v85, 0
    v_mov_b32 v86, 0
    v_mov_b32 v87, 0
    v_mov_b32 v88, 0
    v_mov_b32 v89, 0
    v_mov_b32 v90, 0
    v_mov_b32 v91, 0
    v_mov_b32 v92, 0
    v_mov_b32 v93, 0
    v_mov_b32 v94, 0
    v_mov_b32 v95, 0
    v_mov_b32 v232, 0xff800000
    v_mov_b32 v233, 0
    s_mov_b32 s60, 1040356334
    s_setpc_b64 s[96:97]
TAIL_SETUP:
    s_and_b32 s80, s5, 3
    s_lshr_b32 s81, s5, 2
    s_lshl_b32 s42, s3, 13
    v_lshlrev_b32 v226, 4, v255
    s_lshl_b32 s87, s4, 2
    s_add_u32 s87, s87, s3
    s_cmp_eq_u32 s93, 1
    s_cselect_b32 s10, s34, s24
    s_cselect_b32 s11, s35, s25
    s_lshl_b32 s8, s81, 7
    s_add_u32 s48, s10, s8
    s_addc_u32 s49, s11, 0
    s_sub_u32 s9, 4194304, s8
    s_and_b32 s49, s49, 0xffff
    s_mov_b32 s50, s9
    s_mov_b32 s51, 0x20000
    s_lshl_b32 s88, s87, 17
    s_mov_b32 s89, s42
    v_lshrrev_b32 v246, 3, v255
    v_lshlrev_b32 v246, 10, v246
    v_and_b32 v192, 7, v255
    v_lshl_add_u32 v246, v192, 4, v246
    v_lshrrev_b32 v192, 5, v255
    v_lshlrev_b32 v192, 2, v192
    v_bfe_u32 v193, v255, 2, 2
    v_add_u32 v192, v192, v193
    v_lshlrev_b32 v192, 7, v192
    v_bfe_u32 v193, v255, 4, 1
    v_lshl_add_u32 v192, v193, 5, v192
    v_and_b32 v193, 3, v255
    v_lshl_add_u32 v192, v193, 3, v192
    s_and_b32 s8, s3, 1
    s_lshl_b32 s8, s8, 6
    s_add_u32 s9, s42, s8
    v_add_u32 v247, s9, v192
    s_xor_b32 s9, s9, 64
    v_add_u32 v248, s9, v192
    s_lshl_b32 s8, s93, 3
    s_lshl_b32 s9, s80, 1
    s_add_u32 s8, s8, s9
    s_lshl_b32 s8, s8, 5
    s_add_u32 s8, s8, s87
    s_lshl_b32 s9, s8, 13
    s_add_u32 s9, s9, 4194304
    s_add_u32 s44, s40, s9
    s_addc_u32 s45, s41, 0
    s_and_b32 s45, s45, 0xffff
    s_mov_b32 s46, 270336
    s_mov_b32 s47, 0x20000
    s_lshr_b32 s9, s3, 1
    s_lshl_b32 s72, s9, 18
    s_add_u32 s73, s72, 4096
    s_xor_b32 s74, s72, 262144
    s_add_u32 s75, s74, 4096
    s_lshl_b32 s8, s8, 7
    s_add_u32 s8, s8, 65536
    s_lshl_b32 s9, s9, 12
    s_add_u32 s10, s8, s9
    v_mov_b32 v230, s10
    s_xor_b32 s9, s9, 4096
    s_add_u32 s10, s8, s9
    v_mov_b32 v231, s10
    s_lshl_b32 s8, s6, 5
    s_lshl_b32 s9, s93, 8
    s_add_u32 s8, s8, s9
    s_add_u32 s8, s8, s7
    s_lshl_b32 s8, s8, 7
    s_add_u32 s8, s8, 65536
    v_mov_b32 v147, s8
    s_lshl_b32 s8, s93, 5
    s_lshl_b32 s9, s80, 3
    s_add_u32 s8, s8, s9
    s_add_u32 s8, s8, s81
    s_lshl_b32 s9, s8, 17
    s_add_u32 s9, s9, 25165824
    s_add_u32 s16, s40, s9
    s_addc_u32 s17, s41, 0
    s_and_b32 s17, s17, 0xffff
    s_mov_b32 s18, 131072
    s_mov_b32 s19, 0x20000
    s_lshl_b32 s76, s4, 14
    s_lshl_b32 s8, s3, 12
    s_add_u32 s76, s76, s8
    s_mov_b32 s77, 65536
    s_lshr_b32 s8, s4, 2
    s_lshl_b32 s8, s8, 13
    s_and_b32 s9, s3, 1
    s_lshl_b32 s9, s9, 12
    s_add_u32 s8, s8, s9
    s_and_b32 s9, s4, 3
    s_lshl_b32 s9, s9, 7
    s_add_u32 s8, s8, s9
    v_lshrrev_b32 v192, 4, v255
    v_bfe_u32 v193, v255, 3, 1
    v_and_b32 v194, 7, v255
    v_lshlrev_b32 v195, 14, v192
    v_lshl_add_u32 v195, v193, 9, v195
    v_lshl_add_u32 v195, v194, 4, v195
    v_add_u32 v195, s8, v195
    s_lshr_b32 s8, s3, 1
    s_lshl_b32 s9, s8, 10
    v_add_u32 v227, s9, v195
    s_lshl_b32 s9, s8, 3
    s_add_u32 s9, s9, 2048
    v_add_u32 v228, s9, v195
    s_lshl_b32 s8, s80, 1
    s_lshr_b32 s9, s4, 2
    s_add_u32 s8, s8, s9
    s_lshl_b32 s8, s8, 16
    s_and_b32 s9, s4, 3
    s_lshl_b32 s9, s9, 14
    s_add_u32 s8, s8, s9
    s_lshl_b32 s9, s93, 10
    s_add_u32 s8, s8, s9
    s_lshl_b32 s9, s81, 7
    s_add_u32 s8, s8, s9
    s_and_b32 s9, s3, 1
    s_lshl_b32 s9, s9, 6
    s_add_u32 s8, s8, s9
    s_lshr_b32 s9, s3, 1
    s_lshl_b32 s9, s9, 4
    s_add_u32 s8, s8, s9
    v_lshlrev_b32 v195, 11, v194
    v_lshl_add_u32 v195, v193, 5, v195
    v_lshl_add_u32 v195, v192, 2, v195
    v_add_u32 v229, s8, v195
    s_mov_b32 s20, 0
    s_mov_b32 s21, -1
    s_add_u32 s8, s62, 7168
    v_lshlrev_b32 v192, 2, v255
    v_add_u32 v136, s8, v192
    v_add_u32 v137, s63, v226
    s_lshl_b32 s9, s3, 12
    s_add_u32 s9, s9, 65536
    v_add_u32 v138, s9, v226
    v_and_b32 v192, 31, v255
    v_lshlrev_b32 v192, 2, v192
    s_sub_u32 s8, s3, 0
    s_and_b32 s8, s8, 3
    s_lshl_b32 s9, s8, 13
    s_add_u32 s10, s9, 7168
    v_add_u32 v139, s10, v192
    s_sub_u32 s8, s3, 1
    s_and_b32 s8, s8, 3
    s_lshl_b32 s9, s8, 13
    s_add_u32 s10, s9, 7168
    v_add_u32 v140, s10, v192
    s_add_u32 s9, s9, 32768
    v_add_u32 v143, s9, v226
    s_sub_u32 s8, s3, 2
    s_and_b32 s8, s8, 3
    s_lshl_b32 s9, s8, 13
    s_add_u32 s10, s9, 7168
    v_add_u32 v141, s10, v192
    s_add_u32 s9, s9, 36864
    v_add_u32 v144, s9, v226
    s_sub_u32 s8, s3, 3
    s_and_b32 s8, s8, 3
    s_lshl_b32 s9, s8, 13
    s_add_u32 s10, s9, 7168
    v_add_u32 v142, s10, v192
    s_lshl_b32 s9, s8, 12
    s_add_u32 s9, s9, 65536
    v_add_u32 v145, s9, v226
    s_lshl_b32 s8, s3, 11
    v_add_u32 v146, s8, v226
    s_setpc_b64 s[96:97]
SUB_SOFT:
    ds_read_b64_tr_b16 v[96:97], v242 offset:0
    ds_read_b64_tr_b16 v[98:99], v242 offset:2048
    ds_read_b64_tr_b16 v[104:105], v243 offset:0
    ds_read_b64_tr_b16 v[106:107], v243 offset:2048
    ds_read_b64_tr_b16 v[112:113], v244 offset:0
    ds_read_b64_tr_b16 v[114:115], v244 offset:2048
    ds_read_b64_tr_b16 v[120:121], v245 offset:0
    ds_read_b64_tr_b16 v[122:123], v245 offset:2048
    ds_read_b64_tr_b16 v[100:101], v242 offset:4096
    ds_read_b64_tr_b16 v[102:103], v242 offset:6144
    ds_read_b64_tr_b16 v[108:109], v243 offset:4096
    ds_read_b64_tr_b16 v[110:111], v243 offset:6144
    ds_read_b64_tr_b16 v[116:117], v244 offset:4096
    ds_read_b64_tr_b16 v[118:119], v244 offset:6144
    ds_read_b64_tr_b16 v[124:125], v245 offset:4096
    ds_read_b64_tr_b16 v[126:127], v245 offset:6144
    v_max3_f32 v216, v192, v193, v194
    v_max3_f32 v217, v195, v196, v197
    v_max3_f32 v216, v216, v198, v199
    v_max3_f32 v217, v217, v200, v201
    v_max3_f32 v216, v216, v202, v203
    v_max3_f32 v217, v217, v204, v205
    v_max3_f32 v216, v216, v206, v207
    v_max_f32 v216, v216, v217
    v_mov_b32 v217, v216
    s_nop 1
    v_permlane32_swap_b32 v216, v217
    v_max3_f32 v216, v216, v217, v232
    v_cmp_gt_f32 s[68:69], v216, v232
    s_cmp_eq_u64 s[68:69], 0
    s_cbranch_scc1 L_skip_9
    v_sub_f32 v217, v232, v216
    v_mul_f32 v217, s60, v217
    v_exp_f32 v217, v217
    v_mov_b32 v232, v216
    v_mul_f32 v233, v233, v217
    v_mul_f32 v32, v32, v217
    v_mul_f32 v33, v33, v217
    v_mul_f32 v34, v34, v217
    v_mul_f32 v35, v35, v217
    v_mul_f32 v36, v36, v217
    v_mul_f32 v37, v37, v217
    v_mul_f32 v38, v38, v217
    v_mul_f32 v39, v39, v217
    v_mul_f32 v40, v40, v217
    v_mul_f32 v41, v41, v217
    v_mul_f32 v42, v42, v217
    v_mul_f32 v43, v43, v217
    v_mul_f32 v44, v44, v217
    v_mul_f32 v45, v45, v217
    v_mul_f32 v46, v46, v217
    v_mul_f32 v47, v47, v217
    v_mul_f32 v48, v48, v217
    v_mul_f32 v49, v49, v217
    v_mul_f32 v50, v50, v217
    v_mul_f32 v51, v51, v217
    v_mul_f32 v52, v52, v217
    v_mul_f32 v53, v53, v217
    v_mul_f32 v54, v54, v217
    v_mul_f32 v55, v55, v217
    v_mul_f32 v56, v56, v217
    v_mul_f32 v57, v57, v217
    v_mul_f32 v58, v58, v217
    v_mul_f32 v59, v59, v217
    v_mul_f32 v60, v60, v217
    v_mul_f32 v61, v61, v217
    v_mul_f32 v62, v62, v217
    v_mul_f32 v63, v63, v217
    v_mul_f32 v64, v64, v217
    v_mul_f32 v65, v65, v217
    v_mul_f32 v66, v66, v217
    v_mul_f32 v67, v67, v217
    v_mul_f32 v68, v68, v217
    v_mul_f32 v69, v69, v217
    v_mul_f32 v70, v70, v217
    v_mul_f32 v71, v71, v217
    v_mul_f32 v72, v72, v217
    v_mul_f32 v73, v73, v217
    v_mul_f32 v74, v74, v217
    v_mul_f32 v75, v75, v217
    v_mul_f32 v76, v76, v217
    v_mul_f32 v77, v77, v217
    v_mul_f32 v78, v78, v217
    v_mul_f32 v79, v79, v217
    v_mul_f32 v80, v80, v217
    v_mul_f32 v81, v81, v217
    v_mul_f32 v82, v82, v217
    v_mul_f32 v83, v83, v217
    v_mul_f32 v84, v84, v217
    v_mul_f32 v85, v85, v217
    v_mul_f32 v86, v86, v217
    v_mul_f32 v87, v87, v217
    v_mul_f32 v88, v88, v217
    v_mul_f32 v89, v89, v217
    v_mul_f32 v90, v90, v217
    v_mul_f32 v91, v91, v217
    v_mul_f32 v92, v92, v217
    v_mul_f32 v93, v93, v217
    v_mul_f32 v94, v94, v217
    v_mul_f32 v95, v95, v217
L_skip_9:
    v_mul_f32 v217, s60, v232
    v_fma_f32 v192, v192, s60, -v217
    v_fma_f32 v193, v193, s60, -v217
    v_fma_f32 v194, v194, s60, -v217
    v_fma_f32 v195, v195, s60, -v217
    v_fma_f32 v196, v196, s60, -v217
    v_fma_f32 v197, v197, s60, -v217
    v_fma_f32 v198, v198, s60, -v217
    v_fma_f32 v199, v199, s60, -v217
    v_fma_f32 v200, v200, s60, -v217
    v_fma_f32 v201, v201, s60, -v217
    v_fma_f32 v202, v202, s60, -v217
    v_fma_f32 v203, v203, s60, -v217
    v_fma_f32 v204, v204, s60, -v217
    v_fma_f32 v205, v205, s60, -v217
    v_fma_f32 v206, v206, s60, -v217
    v_fma_f32 v207, v207, s60, -v217
    v_exp_f32 v192, v192
    v_exp_f32 v193, v193
    v_exp_f32 v194, v194
    v_exp_f32 v195, v195
    v_exp_f32 v196, v196
    v_exp_f32 v197, v197
    v_exp_f32 v198, v198
    v_exp_f32 v199, v199
    v_exp_f32 v200, v200
    v_exp_f32 v201, v201
    v_exp_f32 v202, v202
    v_exp_f32 v203, v203
    v_exp_f32 v204, v204
    v_exp_f32 v205, v205
    v_exp_f32 v206, v206
    v_exp_f32 v207, v207
    v_cvt_pk_bf16_f32 v208, v192, v193
    v_cvt_pk_bf16_f32 v209, v194, v195
    v_cvt_pk_bf16_f32 v210, v196, v197
    v_cvt_pk_bf16_f32 v211, v198, v199
    v_cvt_pk_bf16_f32 v212, v200, v201
    v_cvt_pk_bf16_f32 v213, v202, v203
    v_cvt_pk_bf16_f32 v214, v204, v205
    v_cvt_pk_bf16_f32 v215, v206, v207
    v_add_f32 v216, v192, v193
    v_add_f32 v217, v194, v195
    v_add_f32 v216, v216, v196
    v_add_f32 v216, v216, v197
    v_add_f32 v217, v217, v198
    v_add_f32 v217, v217, v199
    v_add_f32 v216, v216, v200
    v_add_f32 v216, v216, v201
    v_add_f32 v217, v217, v202
    v_add_f32 v217, v217, v203
    v_add_f32 v216, v216, v204
    v_add_f32 v216, v216, v205
    v_add_f32 v217, v217, v206
    v_add_f32 v217, v217, v207
    v_add_f32 v216, v216, v217
    v_add_f32 v233, v233, v216
    s_waitcnt lgkmcnt(0)
    s_setpc_b64 s[96:97]
SUB_SOFT2:
    s_nop 10
    v_max3_f32 v216, v192, v193, v194
    v_max3_f32 v217, v195, v196, v197
    v_max3_f32 v216, v216, v198, v199
    v_max3_f32 v217, v217, v200, v201
    v_max3_f32 v216, v216, v202, v203
    v_max3_f32 v217, v217, v204, v205
    v_max3_f32 v216, v216, v206, v207
    v_max_f32 v216, v216, v217
    v_mov_b32 v217, v216
    s_nop 1
    v_permlane32_swap_b32 v216, v217
    v_max3_f32 v216, v216, v217, v232
    v_cmp_gt_f32 s[68:69], v216, v232
    s_cmp_eq_u64 s[68:69], 0
    s_cbranch_scc1 L_skip_10
    v_sub_f32 v217, v232, v216
    v_mul_f32 v217, s60, v217
    v_exp_f32 v217, v217
    v_mov_b32 v232, v216
    v_mul_f32 v233, v233, v217
    v_mul_f32 v32, v32, v217
    v_mul_f32 v33, v33, v217
    v_mul_f32 v34, v34, v217
    v_mul_f32 v35, v35, v217
    v_mul_f32 v36, v36, v217
    v_mul_f32 v37, v37, v217
    v_mul_f32 v38, v38, v217
    v_mul_f32 v39, v39, v217
    v_mul_f32 v40, v40, v217
    v_mul_f32 v41, v41, v217
    v_mul_f32 v42, v42, v217
    v_mul_f32 v43, v43, v217
    v_mul_f32 v44, v44, v217
    v_mul_f32 v45, v45, v217
    v_mul_f32 v46, v46, v217
    v_mul_f32 v47, v47, v217
    v_mul_f32 v48, v48, v217
    v_mul_f32 v49, v49, v217
    v_mul_f32 v50, v50, v217
    v_mul_f32 v51, v51, v217
    v_mul_f32 v52, v52, v217
    v_mul_f32 v53, v53, v217
    v_mul_f32 v54, v54, v217
    v_mul_f32 v55, v55, v217
    v_mul_f32 v56, v56, v217
    v_mul_f32 v57, v57, v217
    v_mul_f32 v58, v58, v217
    v_mul_f32 v59, v59, v217
    v_mul_f32 v60, v60, v217
    v_mul_f32 v61, v61, v217
    v_mul_f32 v62, v62, v217
    v_mul_f32 v63, v63, v217
    v_mul_f32 v64, v64, v217
    v_mul_f32 v65, v65, v217
    v_mul_f32 v66, v66, v217
    v_mul_f32 v67, v67, v217
    v_mul_f32 v68, v68, v217
    v_mul_f32 v69, v69, v217
    v_mul_f32 v70, v70, v217
    v_mul_f32 v71, v71, v217
    v_mul_f32 v72, v72, v217
    v_mul_f32 v73, v73, v217
    v_mul_f32 v74, v74, v217
    v_mul_f32 v75, v75, v217
    v_mul_f32 v76, v76, v217
    v_mul_f32 v77, v77, v217
    v_mul_f32 v78, v78, v217
    v_mul_f32 v79, v79, v217
    v_mul_f32 v80, v80, v217
    v_mul_f32 v81, v81, v217
    v_mul_f32 v82, v82, v217
    v_mul_f32 v83, v83, v217
    v_mul_f32 v84, v84, v217
    v_mul_f32 v85, v85, v217
    v_mul_f32 v86, v86, v217
    v_mul_f32 v87, v87, v217
    v_mul_f32 v88, v88, v217
    v_mul_f32 v89, v89, v217
    v_mul_f32 v90, v90, v217
    v_mul_f32 v91, v91, v217
    v_mul_f32 v92, v92, v217
    v_mul_f32 v93, v93, v217
    v_mul_f32 v94, v94, v217
    v_mul_f32 v95, v95, v217
L_skip_10:
    v_mul_f32 v217, s60, v232
    v_fma_f32 v192, v192, s60, -v217
    v_fma_f32 v193, v193, s60, -v217
    v_fma_f32 v194, v194, s60, -v217
    v_fma_f32 v195, v195, s60, -v217
    v_fma_f32 v196, v196, s60, -v217
    v_fma_f32 v197, v197, s60, -v217
    v_fma_f32 v198, v198, s60, -v217
    v_fma_f32 v199, v199, s60, -v217
    v_fma_f32 v200, v200, s60, -v217
    v_fma_f32 v201, v201, s60, -v217
    v_fma_f32 v202, v202, s60, -v217
    v_fma_f32 v203, v203, s60, -v217
    v_fma_f32 v204, v204, s60, -v217
    v_fma_f32 v205, v205, s60, -v217
    v_fma_f32 v206, v206, s60, -v217
    v_fma_f32 v207, v207, s60, -v217
    v_exp_f32 v192, v192
    v_exp_f32 v193, v193
    v_exp_f32 v194, v194
    v_exp_f32 v195, v195
    v_exp_f32 v196, v196
    v_exp_f32 v197, v197
    v_exp_f32 v198, v198
    v_exp_f32 v199, v199
    v_exp_f32 v200, v200
    v_exp_f32 v201, v201
    v_exp_f32 v202, v202
    v_exp_f32 v203, v203
    v_exp_f32 v204, v204
    v_exp_f32 v205, v205
    v_exp_f32 v206, v206
    v_exp_f32 v207, v207
    v_cvt_pk_bf16_f32 v208, v192, v193
    v_cvt_pk_bf16_f32 v209, v194, v195
    v_cvt_pk_bf16_f32 v210, v196, v197
    v_cvt_pk_bf16_f32 v211, v198, v199
    v_cvt_pk_bf16_f32 v212, v200, v201
    v_cvt_pk_bf16_f32 v213, v202, v203
    v_cvt_pk_bf16_f32 v214, v204, v205
    v_cvt_pk_bf16_f32 v215, v206, v207
    v_add_f32 v216, v192, v193
    v_add_f32 v217, v194, v195
    v_add_f32 v216, v216, v196
    v_add_f32 v216, v216, v197
    v_add_f32 v217, v217, v198
    v_add_f32 v217, v217, v199
    v_add_f32 v216, v216, v200
    v_add_f32 v216, v216, v201
    v_add_f32 v217, v217, v202
    v_add_f32 v217, v217, v203
    v_add_f32 v216, v216, v204
    v_add_f32 v216, v216, v205
    v_add_f32 v217, v217, v206
    v_add_f32 v217, v217, v207
    v_add_f32 v216, v216, v217
    v_add_f32 v233, v233, v216
    s_setpc_b64 s[96:97]
ROLE_A:
    s_setprio 2
    s_cmp_eq_u32 s2, 256
    s_cbranch_scc0 A_noep
    s_cmp_eq_u32 s3, 0
    s_cbranch_scc0 A_noep
    v_mov_b32 v248, 0
    global_load_dword v247, v248, s[40:41] sc1
A_noep:
    s_and_b32 s8, s5, 3
    s_lshr_b32 s6, s5, 2
    s_lshl_b32 s7, s4, 2
    s_add_u32 s7, s7, s8
    s_lshl_b32 s8, s6, 15
    s_add_u32 s44, s16, s8
    s_addc_u32 s45, s17, 0
    s_and_b32 s45, s45, 0xffff
    s_mov_b32 s46, 32768
    s_mov_b32 s47, 0x20000
    s_lshl_b32 s8, s7, 8
    s_add_u32 s48, s22, s8
    s_addc_u32 s49, s23, 0
    s_sub_u32 s9, 4194304, s8
    s_and_b32 s49, s49, 0xffff
    s_mov_b32 s50, s9
    s_mov_b32 s51, 0x20000
    s_and_b32 s67, s6, 3
    s_lshl_b32 s8, s6, 5
    s_add_u32 s8, s8, s7
    s_lshl_b32 s86, s6, 3
    s_lshr_b32 s9, s7, 2
    s_add_u32 s86, s86, s9
    s_lshl_b32 s9, s86, 19
    s_lshr_b32 s10, s86, 13
    s_add_u32 s52, s18, s9
    s_addc_u32 s53, s19, s10
    s_and_b32 s53, s53, 0xffff
    s_mov_b32 s54, 524288
    s_mov_b32 s55, 0x20000
    s_add_u32 s56, s20, s9
    s_addc_u32 s57, s21, s10
    s_and_b32 s57, s57, 0xffff
    s_mov_b32 s58, 524288
    s_mov_b32 s59, 0x20000
    s_lshl_b32 s8, s8, 13
    s_add_u32 s8, s8, 4194304
    s_add_u32 s70, s40, s8
    s_addc_u32 s71, s41, 0
    v_lshrrev_b32 v244, 4, v255
    v_and_b32 v245, 15, v255
    v_add_u32 v246, 0, v244
    v_xor_b32 v246, v246, v245
    v_lshlrev_b32 v246, 4, v246
    v_lshl_add_u32 v250, v244, 8, v246
    v_add_u32 v246, 4, v244
    v_xor_b32 v246, v246, v245
    v_lshlrev_b32 v246, 4, v246
    v_lshl_add_u32 v251, v244, 8, v246
    v_add_u32 v246, 8, v244
    v_xor_b32 v246, v246, v245
    v_lshlrev_b32 v246, 4, v246
    v_lshl_add_u32 v252, v244, 8, v246
    v_add_u32 v246, 12, v244
    v_xor_b32 v246, v246, v245
    v_lshlrev_b32 v246, 4, v246
    v_lshl_add_u32 v253, v244, 8, v246
    v_lshlrev_b32 v246, 2, v244
    v_xor_b32 v246, v246, v245
    v_lshlrev_b32 v246, 4, v246
    v_lshl_add_u32 v254, v244, 8, v246
    s_lshl_b32 s62, s3, 13
    s_add_u32 s63, s62, 32768
    s_mul_i32 s64, s86, 5
    s_mul_i32 s8, s3, 3
    s_add_u32 s64, s64, s8
    s_and_b32 s64, s64, 15
    s_lshl_b32 s64, s64, 13
    s_lshl_b32 s65, s3, 17
    s_add_u32 s66, s65, s64
    v_and_b32 v240, 3, v255
    v_add_u32 v240, s3, v240
    v_and_b32 v240, 3, v240
    v_and_b32 v241, 12, v255
    v_or_b32 v240, v240, v241
    v_lshlrev_b32 v240, 4, v240
    v_lshrrev_b32 v241, 4, v255
    v_lshlrev_b32 v242, 17, v241
    v_add_u32 v240, v240, v242
    v_lshrrev_b32 v242, 3, v255
    s_and_b32 s8, s67, 1
    v_xor_b32 v242, s8, v242
    v_lshlrev_b32 v242, 4, v242
    v_and_b32 v241, 7, v255
    v_lshl_add_u32 v242, v241, 10, v242
    v_add_u32 v243, 16384, v242
    s_lshr_b32 s8, s67, 1
    s_add_u32 s8, s8, 0
    s_and_b32 s8, s8, 1
    s_lshl_b32 s9, s3, 1
    s_add_u32 s8, s8, s9
    s_lshl_b32 s8, s8, 7
    s_add_u32 s9, s8, 8192
    buffer_load_dwordx4 v[128:131], v242, s[44:47], s8 offen
    buffer_load_dwordx4 v[136:139], v242, s[44:47], s9 offen
    buffer_load_dwordx4 v[132:135], v243, s[44:47], s8 offen
    buffer_load_dwordx4 v[140:143], v243, s[44:47], s9 offen
    s_lshr_b32 s8, s67, 1
    s_add_u32 s8, s8, 1
    s_and_b32 s8, s8, 1
    s_lshl_b32 s9, s3, 1
    s_add_u32 s8, s8, s9
    s_lshl_b32 s8, s8, 7
    s_add_u32 s9, s8, 8192
    buffer_load_dwordx4 v[144:147], v242, s[44:47], s8 offen
    buffer_load_dwordx4 v[152:155], v242, s[44:47], s9 offen
    buffer_load_dwordx4 v[148:151], v243, s[44:47], s8 offen
    buffer_load_dwordx4 v[156:159], v243, s[44:47], s9 offen
    s_lshr_b32 s8, s67, 1
    s_add_u32 s8, s8, 0
    s_and_b32 s8, s8, 1
    s_lshl_b32 s9, s3, 1
    s_add_u32 s8, s8, s9
    s_lshl_b32 s8, s8, 3
    s_add_u32 s9, s67, 0
    s_and_b32 s9, s9, 1
    s_add_u32 s8, s8, s9
    s_lshl_b32 s9, s8, 16
    buffer_load_dwordx4 v[0:3], v240, s[48:51], s9 offen
    s_add_u32 s11, s9, 8192
    buffer_load_dwordx4 v[4:7], v240, s[48:51], s11 offen
    s_add_u32 s10, s9, 16384
    buffer_load_dwordx4 v[8:11], v240, s[48:51], s10 offen
    s_add_u32 s11, s9, 24576
    buffer_load_dwordx4 v[12:15], v240, s[48:51], s11 offen
    s_add_u32 s10, s9, 32768
    buffer_load_dwordx4 v[16:19], v240, s[48:51], s10 offen
    s_add_u32 s11, s9, 40960
    buffer_load_dwordx4 v[20:23], v240, s[48:51], s11 offen
    s_add_u32 s10, s9, 49152
    buffer_load_dwordx4 v[24:27], v240, s[48:51], s10 offen
    s_add_u32 s11, s9, 57344
    buffer_load_dwordx4 v[28:31], v240, s[48:51], s11 offen
    s_lshr_b32 s8, s67, 1
    s_add_u32 s8, s8, 0
    s_and_b32 s8, s8, 1
    s_lshl_b32 s9, s3, 1
    s_add_u32 s8, s8, s9
    s_lshl_b32 s8, s8, 3
    s_add_u32 s9, s67, 1
    s_and_b32 s9, s9, 1
    s_add_u32 s8, s8, s9
    s_lshl_b32 s9, s8, 16
    buffer_load_dwordx4 v[32:35], v240, s[48:51], s9 offen
    s_add_u32 s11, s9, 8192
    buffer_load_dwordx4 v[36:39], v240, s[48:51], s11 offen
    s_add_u32 s10, s9, 16384
    buffer_load_dwordx4 v[40:43], v240, s[48:51], s10 offen
    s_add_u32 s11, s9, 24576
    buffer_load_dwordx4 v[44:47], v240, s[48:51], s11 offen
    s_add_u32 s10, s9, 32768
    buffer_load_dwordx4 v[48:51], v240, s[48:51], s10 offen
    s_add_u32 s11, s9, 40960
    buffer_load_dwordx4 v[52:55], v240, s[48:51], s11 offen
    s_add_u32 s10, s9, 49152
    buffer_load_dwordx4 v[56:59], v240, s[48:51], s10 offen
    s_add_u32 s11, s9, 57344
    buffer_load_dwordx4 v[60:63], v240, s[48:51], s11 offen
    s_lshr_b32 s8, s67, 1
    s_add_u32 s8, s8, 1
    s_and_b32 s8, s8, 1
    s_lshl_b32 s9, s3, 1
    s_add_u32 s8, s8, s9
    s_lshl_b32 s8, s8, 3
    s_add_u32 s9, s67, 0
    s_and_b32 s9, s9, 1
    s_add_u32 s8, s8, s9
    s_lshl_b32 s9, s8, 16
    buffer_load_dwordx4 v[64:67], v240, s[48:51], s9 offen
    s_add_u32 s11, s9, 8192
    buffer_load_dwordx4 v[68:71], v240, s[48:51], s11 offen
    s_add_u32 s10, s9, 16384
    buffer_load_dwordx4 v[72:75], v240, s[48:51], s10 offen
    s_add_u32 s11, s9, 24576
    buffer_load_dwordx4 v[76:79], v240, s[48:51], s11 offen
    s_add_u32 s10, s9, 32768
    buffer_load_dwordx4 v[80:83], v240, s[48:51], s10 offen
    s_add_u32 s11, s9, 40960
    buffer_load_dwordx4 v[84:87], v240, s[48:51], s11 offen
    s_add_u32 s10, s9, 49152
    buffer_load_dwordx4 v[88:91], v240, s[48:51], s10 offen
    s_add_u32 s11, s9, 57344
    buffer_load_dwordx4 v[92:95], v240, s[48:51], s11 offen
    s_lshr_b32 s8, s67, 1
    s_add_u32 s8, s8, 1
    s_and_b32 s8, s8, 1
    s_lshl_b32 s9, s3, 1
    s_add_u32 s8, s8, s9
    s_lshl_b32 s8, s8, 3
    s_add_u32 s9, s67, 1
    s_and_b32 s9, s9, 1
    s_add_u32 s8, s8, s9
    s_lshl_b32 s9, s8, 16
    buffer_load_dwordx4 v[96:99], v240, s[48:51], s9 offen
    s_add_u32 s11, s9, 8192
    buffer_load_dwordx4 v[100:103], v240, s[48:51], s11 offen
    s_add_u32 s10, s9, 16384
    buffer_load_dwordx4 v[104:107], v240, s[48:51], s10 offen
    s_add_u32 s11, s9, 24576
    buffer_load_dwordx4 v[108:111], v240, s[48:51], s11 offen
    s_add_u32 s10, s9, 32768
    buffer_load_dwordx4 v[112:115], v240, s[48:51], s10 offen
    s_add_u32 s11, s9, 40960
    buffer_load_dwordx4 v[116:119], v240, s[48:51], s11 offen
    s_add_u32 s10, s9, 49152
    buffer_load_dwordx4 v[120:123], v240, s[48:51], s10 offen
    s_add_u32 s11, s9, 57344
    buffer_load_dwordx4 v[124:127], v240, s[48:51], s11 offen
    s_mov_b32 m0, s62
    s_nop 0
    buffer_load_dwordx4 v250, s[52:55], s66 offen offset:0  lds
    buffer_load_dwordx4 v251, s[52:55], s66 offen offset:1024  lds
    buffer_load_dwordx4 v252, s[52:55], s66 offen offset:2048  lds
    buffer_load_dwordx4 v253, s[52:55], s66 offen offset:3072  lds
    s_add_u32 m0, s62, 4096
    s_add_u32 s78, s66, 4096
    buffer_load_dwordx4 v250, s[52:55], s78 offen offset:0  lds
    buffer_load_dwordx4 v251, s[52:55], s78 offen offset:1024  lds
    buffer_load_dwordx4 v252, s[52:55], s78 offen offset:2048  lds
    buffer_load_dwordx4 v253, s[52:55], s78 offen offset:3072  lds
    s_mov_b32 s78, 0x05040100
    s_mov_b32 s79, 0x07060302
    s_waitcnt vmcnt(32)
    v_mov_b32 v160, v128
    v_mov_b32 v161, v129
    v_mov_b32 v162, v130
    v_mov_b32 v163, v131
    v_mov_b32_dpp v128, v136 row_ror:8 row_mask:0xf bank_mask:0xc
    v_mov_b32_dpp v129, v137 row_ror:8 row_mask:0xf bank_mask:0xc
    v_mov_b32_dpp v130, v138 row_ror:8 row_mask:0xf bank_mask:0xc
    v_mov_b32_dpp v131, v139 row_ror:8 row_mask:0xf bank_mask:0xc
    v_mov_b32_dpp v136, v160 row_ror:8 row_mask:0xf bank_mask:0x3
    v_mov_b32_dpp v137, v161 row_ror:8 row_mask:0xf bank_mask:0x3
    v_mov_b32_dpp v138, v162 row_ror:8 row_mask:0xf bank_mask:0x3
    v_mov_b32_dpp v139, v163 row_ror:8 row_mask:0xf bank_mask:0x3
    v_mov_b32 v164, v132
    v_mov_b32 v165, v133
    v_mov_b32 v166, v134
    v_mov_b32 v167, v135
    v_mov_b32_dpp v132, v140 row_ror:8 row_mask:0xf bank_mask:0xc
    v_mov_b32_dpp v133, v141 row_ror:8 row_mask:0xf bank_mask:0xc
    v_mov_b32_dpp v134, v142 row_ror:8 row_mask:0xf bank_mask:0xc
    v_mov_b32_dpp v135, v143 row_ror:8 row_mask:0xf bank_mask:0xc
    v_mov_b32_dpp v140, v164 row_ror:8 row_mask:0xf bank_mask:0x3
    v_mov_b32_dpp v141, v165 row_ror:8 row_mask:0xf bank_mask:0x3
    v_mov_b32_dpp v142, v166 row_ror:8 row_mask:0xf bank_mask:0x3
    v_mov_b32_dpp v143, v167 row_ror:8 row_mask:0xf bank_mask:0x3
    v_perm_b32 v160, v4, v0, s78
    v_perm_b32 v164, v4, v0, s79
    v_perm_b32 v161, v12, v8, s78
    v_perm_b32 v165, v12, v8, s79
    v_perm_b32 v162, v20, v16, s78
    v_perm_b32 v166, v20, v16, s79
    v_perm_b32 v163, v28, v24, s78
    v_perm_b32 v167, v28, v24, s79
    s_nop 0
    v_mfma_f32_16x16x32_bf16 v[176:179], v[160:163], v[128:131], 0
    v_mfma_f32_16x16x32_bf16 v[180:183], v[160:163], v[132:135], 0
    v_mfma_f32_16x16x32_bf16 v[184:187], v[164:167], v[128:131], 0
    v_mfma_f32_16x16x32_bf16 v[188:191], v[164:167], v[132:135], 0
    v_perm_b32 v168, v5, v1, s78
    v_perm_b32 v172, v5, v1, s79
    v_perm_b32 v169, v13, v9, s78
    v_perm_b32 v173, v13, v9, s79
    v_perm_b32 v170, v21, v17, s78
    v_perm_b32 v174, v21, v17, s79
    v_perm_b32 v171, v29, v25, s78
    v_perm_b32 v175, v29, v25, s79
    s_nop 0
    v_mfma_f32_16x16x32_bf16 v[192:195], v[168:171], v[128:131], 0
    v_mfma_f32_16x16x32_bf16 v[196:199], v[168:171], v[132:135], 0
    v_mfma_f32_16x16x32_bf16 v[200:203], v[172:175], v[128:131], 0
    v_mfma_f32_16x16x32_bf16 v[204:207], v[172:175], v[132:135], 0
    v_perm_b32 v160, v6, v2, s78
    v_perm_b32 v164, v6, v2, s79
    v_perm_b32 v161, v14, v10, s78
    v_perm_b32 v165, v14, v10, s79
    v_perm_b32 v162, v22, v18, s78
    v_perm_b32 v166, v22, v18, s79
    v_perm_b32 v163, v30, v26, s78
    v_perm_b32 v167, v30, v26, s79
    s_nop 0
    v_mfma_f32_16x16x32_bf16 v[208:211], v[160:163], v[128:131], 0
    v_mfma_f32_16x16x32_bf16 v[212:215], v[160:163], v[132:135], 0
    v_mfma_f32_16x16x32_bf16 v[216:219], v[164:167], v[128:131], 0
    v_mfma_f32_16x16x32_bf16 v[220:223], v[164:167], v[132:135], 0
    v_perm_b32 v168, v7, v3, s78
    v_perm_b32 v172, v7, v3, s79
    v_perm_b32 v169, v15, v11, s78
    v_perm_b32 v173, v15, v11, s79
    v_perm_b32 v170, v23, v19, s78
    v_perm_b32 v174, v23, v19, s79
    v_perm_b32 v171, v31, v27, s78
    v_perm_b32 v175, v31, v27, s79
    s_nop 0
    v_mfma_f32_16x16x32_bf16 v[224:227], v[168:171], v[128:131], 0
    v_mfma_f32_16x16x32_bf16 v[228:231], v[168:171], v[132:135], 0
    v_mfma_f32_16x16x32_bf16 v[232:235], v[172:175], v[128:131], 0
    v_mfma_f32_16x16x32_bf16 v[236:239], v[172:175], v[132:135], 0
    s_waitcnt vmcnt(24)
    v_perm_b32 v160, v36, v32, s78
    v_perm_b32 v164, v36, v32, s79
    v_perm_b32 v161, v44, v40, s78
    v_perm_b32 v165, v44, v40, s79
    v_perm_b32 v162, v52, v48, s78
    v_perm_b32 v166, v52, v48, s79
    v_perm_b32 v163, v60, v56, s78
    v_perm_b32 v167, v60, v56, s79
    s_nop 0
    v_mfma_f32_16x16x32_bf16 v[176:179], v[160:163], v[136:139], v[176:179]
    v_mfma_f32_16x16x32_bf16 v[180:183], v[160:163], v[140:143], v[180:183]
    v_mfma_f32_16x16x32_bf16 v[184:187], v[164:167], v[136:139], v[184:187]
    v_mfma_f32_16x16x32_bf16 v[188:191], v[164:167], v[140:143], v[188:191]
    v_perm_b32 v168, v37, v33, s78
    v_perm_b32 v172, v37, v33, s79
    v_perm_b32 v169, v45, v41, s78
    v_perm_b32 v173, v45, v41, s79
    v_perm_b32 v170, v53, v49, s78
    v_perm_b32 v174, v53, v49, s79
    v_perm_b32 v171, v61, v57, s78
    v_perm_b32 v175, v61, v57, s79
    s_nop 0
    v_mfma_f32_16x16x32_bf16 v[192:195], v[168:171], v[136:139], v[192:195]
    v_mfma_f32_16x16x32_bf16 v[196:199], v[168:171], v[140:143], v[196:199]
    v_mfma_f32_16x16x32_bf16 v[200:203], v[172:175], v[136:139], v[200:203]
    v_mfma_f32_16x16x32_bf16 v[204:207], v[172:175], v[140:143], v[204:207]
    v_perm_b32 v160, v38, v34, s78
    v_perm_b32 v164, v38, v34, s79
    v_perm_b32 v161, v46, v42, s78
    v_perm_b32 v165, v46, v42, s79
    v_perm_b32 v162, v54, v50, s78
    v_perm_b32 v166, v54, v50, s79
    v_perm_b32 v163, v62, v58, s78
    v_perm_b32 v167, v62, v58, s79
    s_nop 0
    v_mfma_f32_16x16x32_bf16 v[208:211], v[160:163], v[136:139], v[208:211]
    v_mfma_f32_16x16x32_bf16 v[212:215], v[160:163], v[140:143], v[212:215]
    v_mfma_f32_16x16x32_bf16 v[216:219], v[164:167], v[136:139], v[216:219]
    v_mfma_f32_16x16x32_bf16 v[220:223], v[164:167], v[140:143], v[220:223]
    v_perm_b32 v168, v39, v35, s78
    v_perm_b32 v172, v39, v35, s79
    v_perm_b32 v169, v47, v43, s78
    v_perm_b32 v173, v47, v43, s79
    v_perm_b32 v170, v55, v51, s78
    v_perm_b32 v174, v55, v51, s79
    v_perm_b32 v171, v63, v59, s78
    v_perm_b32 v175, v63, v59, s79
    s_nop 0
    v_mfma_f32_16x16x32_bf16 v[224:227], v[168:171], v[136:139], v[224:227]
    v_mfma_f32_16x16x32_bf16 v[228:231], v[168:171], v[140:143], v[228:231]
    v_mfma_f32_16x16x32_bf16 v[232:235], v[172:175], v[136:139], v[232:235]
    v_mfma_f32_16x16x32_bf16 v[236:239], v[172:175], v[140:143], v[236:239]
    s_waitcnt vmcnt(16)
    v_mov_b32 v160, v144
    v_mov_b32 v161, v145
    v_mov_b32 v162, v146
    v_mov_b32 v163, v147
    v_mov_b32_dpp v144, v152 row_ror:8 row_mask:0xf bank_mask:0xc
    v_mov_b32_dpp v145, v153 row_ror:8 row_mask:0xf bank_mask:0xc
    v_mov_b32_dpp v146, v154 row_ror:8 row_mask:0xf bank_mask:0xc
    v_mov_b32_dpp v147, v155 row_ror:8 row_mask:0xf bank_mask:0xc
    v_mov_b32_dpp v152, v160 row_ror:8 row_mask:0xf bank_mask:0x3
    v_mov_b32_dpp v153, v161 row_ror:8 row_mask:0xf bank_mask:0x3
    v_mov_b32_dpp v154, v162 row_ror:8 row_mask:0xf bank_mask:0x3
    v_mov_b32_dpp v155, v163 row_ror:8 row_mask:0xf bank_mask:0x3
    v_mov_b32 v164, v148
    v_mov_b32 v165, v149
    v_mov_b32 v166, v150
    v_mov_b32 v167, v151
    v_mov_b32_dpp v148, v156 row_ror:8 row_mask:0xf bank_mask:0xc
    v_mov_b32_dpp v149, v157 row_ror:8 row_mask:0xf bank_mask:0xc
    v_mov_b32_dpp v150, v158 row_ror:8 row_mask:0xf bank_mask:0xc
    v_mov_b32_dpp v151, v159 row_ror:8 row_mask:0xf bank_mask:0xc
    v_mov_b32_dpp v156, v164 row_ror:8 row_mask:0xf bank_mask:0x3
    v_mov_b32_dpp v157, v165 row_ror:8 row_mask:0xf bank_mask:0x3
    v_mov_b32_dpp v158, v166 row_ror:8 row_mask:0xf bank_mask:0x3
    v_mov_b32_dpp v159, v167 row_ror:8 row_mask:0xf bank_mask:0x3
    v_perm_b32 v160, v68, v64, s78
    v_perm_b32 v164, v68, v64, s79
    v_perm_b32 v161, v76, v72, s78
    v_perm_b32 v165, v76, v72, s79
    v_perm_b32 v162, v84, v80, s78
    v_perm_b32 v166, v84, v80, s79
    v_perm_b32 v163, v92, v88, s78
    v_perm_b32 v167, v92, v88, s79
    s_nop 0
    v_mfma_f32_16x16x32_bf16 v[176:179], v[160:163], v[144:147], v[176:179]
    v_mfma_f32_16x16x32_bf16 v[180:183], v[160:163], v[148:151], v[180:183]
    v_mfma_f32_16x16x32_bf16 v[184:187], v[164:167], v[144:147], v[184:187]
    v_mfma_f32_16x16x32_bf16 v[188:191], v[164:167], v[148:151], v[188:191]
    v_perm_b32 v168, v69, v65, s78
    v_perm_b32 v172, v69, v65, s79
    v_perm_b32 v169, v77, v73, s78
    v_perm_b32 v173, v77, v73, s79
    v_perm_b32 v170, v85, v81, s78
    v_perm_b32 v174, v85, v81, s79
    v_perm_b32 v171, v93, v89, s78
    v_perm_b32 v175, v93, v89, s79
    s_nop 0
    v_mfma_f32_16x16x32_bf16 v[192:195], v[168:171], v[144:147], v[192:195]
    v_mfma_f32_16x16x32_bf16 v[196:199], v[168:171], v[148:151], v[196:199]
    v_mfma_f32_16x16x32_bf16 v[200:203], v[172:175], v[144:147], v[200:203]
    v_mfma_f32_16x16x32_bf16 v[204:207], v[172:175], v[148:151], v[204:207]
    v_perm_b32 v160, v70, v66, s78
    v_perm_b32 v164, v70, v66, s79
    v_perm_b32 v161, v78, v74, s78
    v_perm_b32 v165, v78, v74, s79
    v_perm_b32 v162, v86, v82, s78
    v_perm_b32 v166, v86, v82, s79
    v_perm_b32 v163, v94, v90, s78
    v_perm_b32 v167, v94, v90, s79
    s_nop 0
    v_mfma_f32_16x16x32_bf16 v[208:211], v[160:163], v[144:147], v[208:211]
    v_mfma_f32_16x16x32_bf16 v[212:215], v[160:163], v[148:151], v[212:215]
    v_mfma_f32_16x16x32_bf16 v[216:219], v[164:167], v[144:147], v[216:219]
    v_mfma_f32_16x16x32_bf16 v[220:223], v[164:167], v[148:151], v[220:223]
    v_perm_b32 v168, v71, v67, s78
    v_perm_b32 v172, v71, v67, s79
    v_perm_b32 v169, v79, v75, s78
    v_perm_b32 v173, v79, v75, s79
    v_perm_b32 v170, v87, v83, s78
    v_perm_b32 v174, v87, v83, s79
    v_perm_b32 v171, v95, v91, s78
    v_perm_b32 v175, v95, v91, s79
    s_nop 0
    v_mfma_f32_16x16x32_bf16 v[224:227], v[168:171], v[144:147], v[224:227]
    v_mfma_f32_16x16x32_bf16 v[228:231], v[168:171], v[148:151], v[228:231]
    v_mfma_f32_16x16x32_bf16 v[232:235], v[172:175], v[144:147], v[232:235]
    v_mfma_f32_16x16x32_bf16 v[236:239], v[172:175], v[148:151], v[236:239]
    s_waitcnt vmcnt(8)
    v_perm_b32 v160, v100, v96, s78
    v_perm_b32 v164, v100, v96, s79
    v_perm_b32 v161, v108, v104, s78
    v_perm_b32 v165, v108, v104, s79
    v_perm_b32 v162, v116, v112, s78
    v_perm_b32 v166, v116, v112, s79
    v_perm_b32 v163, v124, v120, s78
    v_perm_b32 v167, v124, v120, s79
    s_nop 0
    v_mfma_f32_16x16x32_bf16 v[176:179], v[160:163], v[152:155], v[176:179]
    v_mfma_f32_16x16x32_bf16 v[180:183], v[160:163], v[156:159], v[180:183]
    v_mfma_f32_16x16x32_bf16 v[184:187], v[164:167], v[152:155], v[184:187]
    v_mfma_f32_16x16x32_bf16 v[188:191], v[164:167], v[156:159], v[188:191]
    v_perm_b32 v168, v101, v97, s78
    v_perm_b32 v172, v101, v97, s79
    v_perm_b32 v169, v109, v105, s78
    v_perm_b32 v173, v109, v105, s79
    v_perm_b32 v170, v117, v113, s78
    v_perm_b32 v174, v117, v113, s79
    v_perm_b32 v171, v125, v121, s78
    v_perm_b32 v175, v125, v121, s79
    s_nop 0
    v_mfma_f32_16x16x32_bf16 v[192:195], v[168:171], v[152:155], v[192:195]
    v_mfma_f32_16x16x32_bf16 v[196:199], v[168:171], v[156:159], v[196:199]
    v_mfma_f32_16x16x32_bf16 v[200:203], v[172:175], v[152:155], v[200:203]
    v_mfma_f32_16x16x32_bf16 v[204:207], v[172:175], v[156:159], v[204:207]
    v_perm_b32 v160, v102, v98, s78
    v_perm_b32 v164, v102, v98, s79
    v_perm_b32 v161, v110, v106, s78
    v_perm_b32 v165, v110, v106, s79
    v_perm_b32 v162, v118, v114, s78
    v_perm_b32 v166, v118, v114, s79
    v_perm_b32 v163, v126, v122, s78
    v_perm_b32 v167, v126, v122, s79
    s_nop 0
    v_mfma_f32_16x16x32_bf16 v[208:211], v[160:163], v[152:155], v[208:211]
    v_mfma_f32_16x16x32_bf16 v[212:215], v[160:163], v[156:159], v[212:215]
    v_mfma_f32_16x16x32_bf16 v[216:219], v[164:167], v[152:155], v[216:219]
    v_mfma_f32_16x16x32_bf16 v[220:223], v[164:167], v[156:159], v[220:223]
    v_perm_b32 v168, v103, v99, s78
    v_perm_b32 v172, v103, v99, s79
    v_perm_b32 v169, v111, v107, s78
    v_perm_b32 v173, v111, v107, s79
    v_perm_b32 v170, v119, v115, s78
    v_perm_b32 v174, v119, v115, s79
    v_perm_b32 v171, v127, v123, s78
    v_perm_b32 v175, v127, v123, s79
    s_nop 0
    v_mfma_f32_16x16x32_bf16 v[224:227], v[168:171], v[152:155], v[224:227]
    v_mfma_f32_16x16x32_bf16 v[228:231], v[168:171], v[156:159], v[228:231]
    v_mfma_f32_16x16x32_bf16 v[232:235], v[172:175], v[152:155], v[232:235]
    v_mfma_f32_16x16x32_bf16 v[236:239], v[172:175], v[156:159], v[236:239]
    s_mov_b32 m0, s63
    s_nop 0
    buffer_load_dwordx4 v254, s[56:59], s66 offen offset:0  lds
    buffer_load_dwordx4 v254, s[56:59], s66 offen offset:1024  lds
    buffer_load_dwordx4 v254, s[56:59], s66 offen offset:2048  lds
    buffer_load_dwordx4 v254, s[56:59], s66 offen offset:3072  lds
    s_add_u32 m0, s63, 4096
    s_add_u32 s80, s66, 4096
    buffer_load_dwordx4 v254, s[56:59], s80 offen offset:0  lds
    buffer_load_dwordx4 v254, s[56:59], s80 offen offset:1024  lds
    buffer_load_dwordx4 v254, s[56:59], s80 offen offset:2048  lds
    buffer_load_dwordx4 v254, s[56:59], s80 offen offset:3072  lds
    v_mov_b32 v0, v177
    v_mov_b32 v1, v185
    v_mov_b32 v2, v193
    v_mov_b32 v3, v201
    v_mov_b32 v4, v209
    v_mov_b32 v5, v217
    v_mov_b32 v6, v225
    v_mov_b32 v7, v233
    v_mov_b32 v8, v181
    v_mov_b32 v9, v189
    v_mov_b32 v10, v197
    v_mov_b32 v11, v205
    v_mov_b32 v12, v213
    v_mov_b32 v13, v221
    v_mov_b32 v14, v229
    v_mov_b32 v15, v237
    v_mov_b32 v16, v178
    v_mov_b32 v17, v186
    v_mov_b32 v18, v194
    v_mov_b32 v19, v202
    v_mov_b32 v20, v210
    v_mov_b32 v21, v218
    v_mov_b32 v22, v226
    v_mov_b32 v23, v234
    v_mov_b32 v24, v182
    v_mov_b32 v25, v190
    v_mov_b32 v26, v198
    v_mov_b32 v27, v206
    v_mov_b32 v28, v214
    v_mov_b32 v29, v222
    v_mov_b32 v30, v230
    v_mov_b32 v31, v238
    v_mov_b32 v32, v179
    v_mov_b32 v33, v187
    v_mov_b32 v34, v195
    v_mov_b32 v35, v203
    v_mov_b32 v36, v211
    v_mov_b32 v37, v219
    v_mov_b32 v38, v227
    v_mov_b32 v39, v235
    v_mov_b32 v40, v183
    v_mov_b32 v41, v191
    v_mov_b32 v42, v199
    v_mov_b32 v43, v207
    v_mov_b32 v44, v215
    v_mov_b32 v45, v223
    v_mov_b32 v46, v231
    v_mov_b32 v47, v239
    v_lshlrev_b32 v245, 4, v255
    s_lshl_b32 s12, s3, 12
    s_add_u32 s12, s12, 65536
    v_add_u32 v246, s12, v245
    s_add_u32 s12, s3, 1
    s_and_b32 s12, s12, 3
    s_lshl_b32 s12, s12, 12
    s_add_u32 s12, s12, 65536
    v_add_u32 v244, s12, v245
    ds_write_b128 v244, v[0:3] offset:0
    ds_write_b128 v244, v[4:7] offset:1024
    ds_write_b128 v244, v[8:11] offset:2048
    ds_write_b128 v244, v[12:15] offset:3072
    s_waitcnt lgkmcnt(0)
    s_barrier
    ds_read_b128 v[48:51], v246 offset:0
    ds_read_b128 v[52:55], v246 offset:1024
    ds_read_b128 v[56:59], v246 offset:2048
    ds_read_b128 v[60:63], v246 offset:3072
    s_waitcnt lgkmcnt(0)
    s_add_u32 s12, s3, 2
    s_and_b32 s12, s12, 3
    s_lshl_b32 s12, s12, 12
    s_add_u32 s12, s12, 65536
    v_add_u32 v244, s12, v245
    s_barrier
    ds_write_b128 v244, v[16:19] offset:0
    ds_write_b128 v244, v[20:23] offset:1024
    ds_write_b128 v244, v[24:27] offset:2048
    ds_write_b128 v244, v[28:31] offset:3072
    v_add_f32 v176, v176, v48
    v_add_f32 v184, v184, v49
    v_add_f32 v192, v192, v50
    v_add_f32 v200, v200, v51
    v_add_f32 v208, v208, v52
    v_add_f32 v216, v216, v53
    v_add_f32 v224, v224, v54
    v_add_f32 v232, v232, v55
    v_add_f32 v180, v180, v56
    v_add_f32 v188, v188, v57
    v_add_f32 v196, v196, v58
    v_add_f32 v204, v204, v59
    v_add_f32 v212, v212, v60
    v_add_f32 v220, v220, v61
    v_add_f32 v228, v228, v62
    v_add_f32 v236, v236, v63
    s_waitcnt lgkmcnt(0)
    s_barrier
    ds_read_b128 v[64:67], v246 offset:0
    ds_read_b128 v[68:71], v246 offset:1024
    ds_read_b128 v[72:75], v246 offset:2048
    ds_read_b128 v[76:79], v246 offset:3072
    s_waitcnt lgkmcnt(0)
    s_add_u32 s12, s3, 3
    s_and_b32 s12, s12, 3
    s_lshl_b32 s12, s12, 12
    s_add_u32 s12, s12, 65536
    v_add_u32 v244, s12, v245
    s_barrier
    ds_write_b128 v244, v[32:35] offset:0
    ds_write_b128 v244, v[36:39] offset:1024
    ds_write_b128 v244, v[40:43] offset:2048
    ds_write_b128 v244, v[44:47] offset:3072
    v_add_f32 v176, v176, v64
    v_add_f32 v184, v184, v65
    v_add_f32 v192, v192, v66
    v_add_f32 v200, v200, v67
    v_add_f32 v208, v208, v68
    v_add_f32 v216, v216, v69
    v_add_f32 v224, v224, v70
    v_add_f32 v232, v232, v71
    v_add_f32 v180, v180, v72
    v_add_f32 v188, v188, v73
    v_add_f32 v196, v196, v74
    v_add_f32 v204, v204, v75
    v_add_f32 v212, v212, v76
    v_add_f32 v220, v220, v77
    v_add_f32 v228, v228, v78
    v_add_f32 v236, v236, v79
    s_waitcnt lgkmcnt(0)
    s_barrier
    ds_read_b128 v[80:83], v246 offset:0
    ds_read_b128 v[84:87], v246 offset:1024
    ds_read_b128 v[88:91], v246 offset:2048
    ds_read_b128 v[92:95], v246 offset:3072
    s_waitcnt lgkmcnt(0)
    v_add_f32 v176, v176, v80
    v_add_f32 v184, v184, v81
    v_add_f32 v192, v192, v82
    v_add_f32 v200, v200, v83
    v_add_f32 v208, v208, v84
    v_add_f32 v216, v216, v85
    v_add_f32 v224, v224, v86
    v_add_f32 v232, v232, v87
    v_add_f32 v180, v180, v88
    v_add_f32 v188, v188, v89
    v_add_f32 v196, v196, v90
    v_add_f32 v204, v204, v91
    v_add_f32 v212, v212, v92
    v_add_f32 v220, v220, v93
    v_add_f32 v228, v228, v94
    v_add_f32 v236, v236, v95
    v_cvt_pk_bf16_f32 v16, v176, v184
    v_cvt_pk_bf16_f32 v17, v192, v200
    v_cvt_pk_bf16_f32 v18, v208, v216
    v_cvt_pk_bf16_f32 v19, v224, v232
    v_cvt_pk_bf16_f32 v20, v180, v188
    v_cvt_pk_bf16_f32 v21, v196, v204
    v_cvt_pk_bf16_f32 v22, v212, v220
    v_cvt_pk_bf16_f32 v23, v228, v236
    s_cmp_eq_u32 s2, 256
    s_cbranch_scc0 A_noep2
    s_cmp_eq_u32 s3, 0
    s_cbranch_scc0 A_noep2
    v_readfirstlane_b32 s8, v247
    s_add_u32 s8, s8, 2654435769
    s_cmp_eq_u32 s8, 0
    s_cselect_b32 s8, 2654435769, s8
    v_mov_b32 v247, s8
    v_mov_b32 v248, 0
    s_mov_b64 exec, 1
    global_store_dword v248, v247, s[40:41] offset:0 sc1
    global_store_dword v248, v247, s[38:39] sc1
    s_mov_b64 exec, -1
A_noep2:
    s_barrier
    v_lshrrev_b32 v224, 4, v255
    v_lshlrev_b32 v224, 11, v224
    v_and_b32 v225, 15, v255
    v_lshl_add_u32 v224, v225, 4, v224
    s_lshl_b32 s8, s3, 9
    s_add_u32 s8, s8, 65536
    v_add_u32 v224, s8, v224
    ds_write_b128 v224, v[16:19]
    ds_write_b128 v224, v[20:23] offset:256
    s_mov_b32 s79, s62
    s_mov_b32 s80, s63
    s_mov_b32 s81, s3
    s_call_b64 s[96:97], SUB_READS
    s_waitcnt lgkmcnt(0)
    s_barrier
    v_lshrrev_b32 v216, 5, v255
    v_lshlrev_b32 v216, 12, v216
    v_and_b32 v217, 31, v255
    v_lshl_add_u32 v216, v217, 4, v216
    v_add_u32 v216, 65536, v216
    ds_read_b128 v[0:3], v216 offset:0
    ds_read_b128 v[4:7], v216 offset:512
    ds_read_b128 v[8:11], v216 offset:1024
    ds_read_b128 v[12:15], v216 offset:1536
    ds_read_b128 v[16:19], v216 offset:2048
    ds_read_b128 v[20:23], v216 offset:2560
    ds_read_b128 v[24:27], v216 offset:3072
    ds_read_b128 v[28:31], v216 offset:3584
    s_mov_b32 s93, 0
    s_mov_b32 s16, s40
    s_mov_b32 s17, s41
    s_and_b32 s17, s17, 0xffff
    s_mov_b32 s18, 131072
    s_mov_b32 s19, 0x20000
    s_mov_b32 s61, 0
    v_mov_b32 v132, 0
    s_setprio 0
A_loop:
    s_waitcnt vmcnt(8)
    ds_read_b128 v[96:99], v234
    ds_read_b128 v[100:103], v235
    ds_read_b128 v[104:107], v236
    ds_read_b128 v[108:111], v237
    ds_read_b128 v[112:115], v238
    ds_read_b128 v[116:119], v239
    ds_read_b128 v[120:123], v240
    ds_read_b128 v[124:127], v241
    s_add_u32 s64, s64, 8192
    s_and_b32 s64, s64, 0x1ffff
    s_add_u32 s66, s65, s64
    s_waitcnt lgkmcnt(0)
    s_cmp_eq_u32 s61, 4
    s_cbranch_scc0 L_nic_11
    global_load_dword v128, v132, s[38:39] sc1
L_nic_11:
    s_cmp_eq_u32 s61, 15
    s_cbranch_scc0 L_knext_12
    s_add_u32 m0, s89, 0
    s_add_u32 s78, s88, 0
    buffer_load_dwordx4 v246, s[48:51], s78 offen  lds
    s_add_u32 m0, s89, 1024
    s_add_u32 s79, s88, 8192
    buffer_load_dwordx4 v246, s[48:51], s79 offen  lds
    s_add_u32 m0, s89, 2048
    s_add_u32 s78, s88, 16384
    buffer_load_dwordx4 v246, s[48:51], s78 offen  lds
    s_add_u32 m0, s89, 3072
    s_add_u32 s79, s88, 24576
    buffer_load_dwordx4 v246, s[48:51], s79 offen  lds
    s_add_u32 m0, s89, 4096
    s_add_u32 s78, s88, 32768
    buffer_load_dwordx4 v246, s[48:51], s78 offen  lds
    s_add_u32 m0, s89, 5120
    s_add_u32 s79, s88, 40960
    buffer_load_dwordx4 v246, s[48:51], s79 offen  lds
    s_add_u32 m0, s89, 6144
    s_add_u32 s78, s88, 49152
    buffer_load_dwordx4 v246, s[48:51], s78 offen  lds
    v_mfma_f32_32x32x16_bf16 v[192:207], v[96:99], v[0:3], 0
    v_mfma_f32_32x32x16_bf16 v[192:207], v[100:103], v[4:7], v[192:207]
    v_mfma_f32_32x32x16_bf16 v[192:207], v[104:107], v[8:11], v[192:207]
    v_mfma_f32_32x32x16_bf16 v[192:207], v[108:111], v[12:15], v[192:207]
    v_mfma_f32_32x32x16_bf16 v[192:207], v[112:115], v[16:19], v[192:207]
    v_mfma_f32_32x32x16_bf16 v[192:207], v[116:119], v[20:23], v[192:207]
    v_mfma_f32_32x32x16_bf16 v[192:207], v[120:123], v[24:27], v[192:207]
    v_mfma_f32_32x32x16_bf16 v[192:207], v[124:127], v[28:31], v[192:207]
    s_waitcnt vmcnt(7)
    s_branch L_kdone_13
L_knext_12:
    s_mov_b32 m0, s62
    s_nop 0
    buffer_load_dwordx4 v250, s[52:55], s66 offen offset:0  lds
    buffer_load_dwordx4 v251, s[52:55], s66 offen offset:1024  lds
    buffer_load_dwordx4 v252, s[52:55], s66 offen offset:2048  lds
    buffer_load_dwordx4 v253, s[52:55], s66 offen offset:3072  lds
    s_add_u32 m0, s62, 4096
    s_add_u32 s78, s66, 4096
    buffer_load_dwordx4 v250, s[52:55], s78 offen offset:0  lds
    buffer_load_dwordx4 v251, s[52:55], s78 offen offset:1024  lds
    buffer_load_dwordx4 v252, s[52:55], s78 offen offset:2048  lds
    buffer_load_dwordx4 v253, s[52:55], s78 offen offset:3072  lds
    v_mfma_f32_32x32x16_bf16 v[192:207], v[96:99], v[0:3], 0
    v_mfma_f32_32x32x16_bf16 v[192:207], v[100:103], v[4:7], v[192:207]
    v_mfma_f32_32x32x16_bf16 v[192:207], v[104:107], v[8:11], v[192:207]
    v_mfma_f32_32x32x16_bf16 v[192:207], v[108:111], v[12:15], v[192:207]
    v_mfma_f32_32x32x16_bf16 v[192:207], v[112:115], v[16:19], v[192:207]
    v_mfma_f32_32x32x16_bf16 v[192:207], v[116:119], v[20:23], v[192:207]
    v_mfma_f32_32x32x16_bf16 v[192:207], v[120:123], v[24:27], v[192:207]
    v_mfma_f32_32x32x16_bf16 v[192:207], v[124:127], v[28:31], v[192:207]
    s_waitcnt vmcnt(8)
L_kdone_13:
    s_call_b64 s[96:97], SUB_SOFT
    s_cmp_eq_u32 s61, 15
    s_cbranch_scc1 L_vskip_14
    s_mov_b32 m0, s63
    s_nop 0
    buffer_load_dwordx4 v254, s[56:59], s66 offen offset:0  lds
    buffer_load_dwordx4 v254, s[56:59], s66 offen offset:1024  lds
    buffer_load_dwordx4 v254, s[56:59], s66 offen offset:2048  lds
    buffer_load_dwordx4 v254, s[56:59], s66 offen offset:3072  lds
    s_add_u32 m0, s63, 4096
    s_add_u32 s78, s66, 4096
    buffer_load_dwordx4 v254, s[56:59], s78 offen offset:0  lds
    buffer_load_dwordx4 v254, s[56:59], s78 offen offset:1024  lds
    buffer_load_dwordx4 v254, s[56:59], s78 offen offset:2048  lds
    buffer_load_dwordx4 v254, s[56:59], s78 offen offset:3072  lds
L_vskip_14:
    s_cmp_eq_u32 s61, 1
    s_cbranch_scc0 L_nts_15
    s_call_b64 s[96:97], TAIL_SETUP
L_nts_15:
    s_cmp_eq_u32 s61, 12
    s_cbranch_scc0 L_nnc_16
    s_mov_b32 s90, 400000
L_ichk_17:
    v_readfirstlane_b32 s91, v128
    s_cmp_lg_u32 s91, 0
    s_cbranch_scc1 L_iok_18
    s_sleep 1
    global_load_dword v128, v132, s[38:39] sc1
    s_waitcnt vmcnt(0)
    s_sub_u32 s90, s90, 1
    s_cmp_lg_u32 s90, 0
    s_cbranch_scc1 L_ichk_17
L_iok_18:
    v_mov_b32 v148, s91
L_nnc_16:
    v_mfma_f32_32x32x16_bf16 v[32:47], v[96:99], v[208:211], v[32:47]
    v_mfma_f32_32x32x16_bf16 v[48:63], v[104:107], v[208:211], v[48:63]
    v_mfma_f32_32x32x16_bf16 v[64:79], v[112:115], v[208:211], v[64:79]
    v_mfma_f32_32x32x16_bf16 v[80:95], v[120:123], v[208:211], v[80:95]
    v_mfma_f32_32x32x16_bf16 v[32:47], v[100:103], v[212:215], v[32:47]
    v_mfma_f32_32x32x16_bf16 v[48:63], v[108:111], v[212:215], v[48:63]
    v_mfma_f32_32x32x16_bf16 v[64:79], v[116:119], v[212:215], v[64:79]
    v_mfma_f32_32x32x16_bf16 v[80:95], v[124:127], v[212:215], v[80:95]
    s_add_u32 s61, s61, 1
    s_cmp_lt_u32 s61, 16
    s_cbranch_scc1 A_loop
    s_setprio 3
    global_load_dword v240, v230, s[40:41] sc1
    global_load_dword v241, v231, s[40:41] sc1
    s_nop 3
    ds_write_b128 v137, v[48:51] offset:0
    ds_write_b128 v137, v[52:55] offset:1024
    ds_write_b128 v137, v[56:59] offset:2048
    ds_write_b128 v137, v[60:63] offset:3072
    ds_write_b128 v137, v[64:67] offset:4096
    ds_write_b128 v137, v[68:71] offset:5120
    ds_write_b128 v137, v[72:75] offset:6144
    ds_write_b128 v137, v[76:79] offset:7168
    ds_write_b128 v138, v[80:83] offset:0
    ds_write_b128 v138, v[84:87] offset:1024
    ds_write_b128 v138, v[88:91] offset:2048
    ds_write_b128 v138, v[92:95] offset:3072
    v_mov_b32 v216, v233
    s_nop 1
    v_permlane32_swap_b32 v233, v216
    v_add_f32 v233, v233, v216
    v_cndmask_b32 v216, v232, v233, s[20:21]
    ds_write_b32 v136, v216
    s_waitcnt lgkmcnt(0)
    s_barrier
    ds_read2_b32 v[218:219], v139 offset0:0 offset1:32
    ds_read2_b32 v[220:221], v140 offset0:0 offset1:32
    ds_read2_b32 v[222:223], v141 offset0:0 offset1:32
    ds_read2_b32 v[224:225], v142 offset0:0 offset1:32
    ds_read_b128 v[0:3], v143 offset:0
    ds_read_b128 v[4:7], v143 offset:1024
    ds_read_b128 v[8:11], v143 offset:2048
    ds_read_b128 v[12:15], v143 offset:3072
    ds_read_b128 v[16:19], v144 offset:0
    ds_read_b128 v[20:23], v144 offset:1024
    ds_read_b128 v[24:27], v144 offset:2048
    ds_read_b128 v[28:31], v144 offset:3072
    ds_read_b128 v[96:99], v145 offset:0
    ds_read_b128 v[100:103], v145 offset:1024
    ds_read_b128 v[104:107], v145 offset:2048
    ds_read_b128 v[108:111], v145 offset:3072
    s_waitcnt lgkmcnt(12)
    v_max3_f32 v216, v218, v220, v222
    v_max_f32 v216, v216, v224
    v_sub_f32 v218, v218, v216
    v_sub_f32 v220, v220, v216
    v_sub_f32 v222, v222, v216
    v_sub_f32 v224, v224, v216
    v_mul_f32 v218, s60, v218
    v_mul_f32 v220, s60, v220
    v_mul_f32 v222, s60, v222
    v_mul_f32 v224, s60, v224
    v_exp_f32 v218, v218
    v_exp_f32 v220, v220
    v_exp_f32 v222, v222
    v_exp_f32 v224, v224
    v_mul_f32 v216, v218, v219
    v_fma_f32 v216, v220, v221, v216
    v_fma_f32 v216, v222, v223, v216
    v_fma_f32 v216, v224, v225, v216
    v_rcp_f32 v216, v216
    s_nop 0
    v_mul_f32 v218, v218, v216
    v_mul_f32 v220, v220, v216
    v_mul_f32 v222, v222, v216
    v_mul_f32 v224, v224, v216
    v_pk_mul_f32 v[32:33], v[32:33], v[218:219] op_sel_hi:[1,0]
    v_pk_mul_f32 v[34:35], v[34:35], v[218:219] op_sel_hi:[1,0]
    v_pk_mul_f32 v[36:37], v[36:37], v[218:219] op_sel_hi:[1,0]
    v_pk_mul_f32 v[38:39], v[38:39], v[218:219] op_sel_hi:[1,0]
    v_pk_mul_f32 v[40:41], v[40:41], v[218:219] op_sel_hi:[1,0]
    v_pk_mul_f32 v[42:43], v[42:43], v[218:219] op_sel_hi:[1,0]
    v_pk_mul_f32 v[44:45], v[44:45], v[218:219] op_sel_hi:[1,0]
    v_pk_mul_f32 v[46:47], v[46:47], v[218:219] op_sel_hi:[1,0]
    s_waitcnt lgkmcnt(8)
    v_pk_fma_f32 v[32:33], v[0:1], v[220:221], v[32:33] op_sel_hi:[1,0,1]
    v_pk_fma_f32 v[34:35], v[2:3], v[220:221], v[34:35] op_sel_hi:[1,0,1]
    v_pk_fma_f32 v[36:37], v[4:5], v[220:221], v[36:37] op_sel_hi:[1,0,1]
    v_pk_fma_f32 v[38:39], v[6:7], v[220:221], v[38:39] op_sel_hi:[1,0,1]
    v_pk_fma_f32 v[40:41], v[8:9], v[220:221], v[40:41] op_sel_hi:[1,0,1]
    v_pk_fma_f32 v[42:43], v[10:11], v[220:221], v[42:43] op_sel_hi:[1,0,1]
    v_pk_fma_f32 v[44:45], v[12:13], v[220:221], v[44:45] op_sel_hi:[1,0,1]
    v_pk_fma_f32 v[46:47], v[14:15], v[220:221], v[46:47] op_sel_hi:[1,0,1]
    s_waitcnt lgkmcnt(4)
    v_pk_fma_f32 v[32:33], v[16:17], v[222:223], v[32:33] op_sel_hi:[1,0,1]
    v_pk_fma_f32 v[34:35], v[18:19], v[222:223], v[34:35] op_sel_hi:[1,0,1]
    v_pk_fma_f32 v[36:37], v[20:21], v[222:223], v[36:37] op_sel_hi:[1,0,1]
    v_pk_fma_f32 v[38:39], v[22:23], v[222:223], v[38:39] op_sel_hi:[1,0,1]
    v_pk_fma_f32 v[40:41], v[24:25], v[222:223], v[40:41] op_sel_hi:[1,0,1]
    v_pk_fma_f32 v[42:43], v[26:27], v[222:223], v[42:43] op_sel_hi:[1,0,1]
    v_pk_fma_f32 v[44:45], v[28:29], v[222:223], v[44:45] op_sel_hi:[1,0,1]
    v_pk_fma_f32 v[46:47], v[30:31], v[222:223], v[46:47] op_sel_hi:[1,0,1]
    s_waitcnt lgkmcnt(0)
    v_pk_fma_f32 v[32:33], v[96:97], v[224:225], v[32:33] op_sel_hi:[1,0,1]
    v_pk_fma_f32 v[34:35], v[98:99], v[224:225], v[34:35] op_sel_hi:[1,0,1]
    v_pk_fma_f32 v[36:37], v[100:101], v[224:225], v[36:37] op_sel_hi:[1,0,1]
    v_pk_fma_f32 v[38:39], v[102:103], v[224:225], v[38:39] op_sel_hi:[1,0,1]
    v_pk_fma_f32 v[40:41], v[104:105], v[224:225], v[40:41] op_sel_hi:[1,0,1]
    v_pk_fma_f32 v[42:43], v[106:107], v[224:225], v[42:43] op_sel_hi:[1,0,1]
    v_pk_fma_f32 v[44:45], v[108:109], v[224:225], v[44:45] op_sel_hi:[1,0,1]
    v_pk_fma_f32 v[46:47], v[110:111], v[224:225], v[46:47] op_sel_hi:[1,0,1]
    v_cvt_pk_bf16_f32 v208, v32, v33
    v_cvt_pk_bf16_f32 v209, v34, v35
    v_cvt_pk_bf16_f32 v210, v36, v37
    v_cvt_pk_bf16_f32 v211, v38, v39
    v_cvt_pk_bf16_f32 v212, v40, v41
    v_cvt_pk_bf16_f32 v213, v42, v43
    v_cvt_pk_bf16_f32 v214, v44, v45
    v_cvt_pk_bf16_f32 v215, v46, v47
    s_waitcnt vmcnt(0)
    global_store_dwordx4 v146, v[208:211], s[70:71] sc1
    global_store_dwordx4 v146, v[212:215], s[70:71] offset:1024 sc1
L_EPI2:
    s_mov_b32 s98, 0
    v_cmp_ne_u32 vcc, s91, v240
    s_cmp_eq_u64 vcc, 0
    s_cselect_b32 s98, 4, 0
    s_mov_b32 s99, 0
    v_cmp_ne_u32 vcc, s91, v241
    s_cmp_eq_u64 vcc, 0
    s_cselect_b32 s99, 4, 0
    s_waitcnt vmcnt(0)
    s_barrier
    s_cmp_lg_u32 s3, 0
    s_cbranch_scc1 L_noflag
    s_mov_b64 exec, 1
    global_store_dword v147, v148, s[40:41] sc1
    s_mov_b64 exec, -1
L_noflag:
    s_add_u32 m0, s89, 7168
    s_add_u32 s78, s88, 57344
    buffer_load_dwordx4 v246, s[48:51], s78 offen  lds
    s_add_u32 m0, s89, 32768
    s_add_u32 s79, s88, 65536
    buffer_load_dwordx4 v246, s[48:51], s79 offen  lds
    s_add_u32 m0, s89, 33792
    s_add_u32 s78, s88, 73728
    buffer_load_dwordx4 v246, s[48:51], s78 offen  lds
    s_add_u32 m0, s89, 34816
    s_add_u32 s79, s88, 81920
    buffer_load_dwordx4 v246, s[48:51], s79 offen  lds
    s_add_u32 m0, s89, 35840
    s_add_u32 s78, s88, 90112
    buffer_load_dwordx4 v246, s[48:51], s78 offen  lds
    s_add_u32 m0, s89, 36864
    s_add_u32 s79, s88, 98304
    buffer_load_dwordx4 v246, s[48:51], s79 offen  lds
    s_add_u32 m0, s89, 37888
    s_add_u32 s78, s88, 106496
    buffer_load_dwordx4 v246, s[48:51], s78 offen  lds
    s_add_u32 m0, s89, 38912
    s_add_u32 s79, s88, 114688
    buffer_load_dwordx4 v246, s[48:51], s79 offen  lds
    s_add_u32 m0, s89, 39936
    s_add_u32 s78, s88, 122880
    buffer_load_dwordx4 v246, s[48:51], s78 offen  lds
    s_mov_b32 s92, 0
    s_cmp_eq_u32 s98, 4
    s_cbranch_scc0 L_ne_19
    s_mov_b32 s98, 1
    s_add_u32 s92, s92, 2
    buffer_load_dwordx4 v[0:3], v226, s[44:47], s72 offen offset:0 sc1
    buffer_load_dwordx4 v[4:7], v226, s[44:47], s72 offen offset:1024 sc1
    buffer_load_dwordx4 v[8:11], v226, s[44:47], s72 offen offset:2048 sc1
    buffer_load_dwordx4 v[12:15], v226, s[44:47], s72 offen offset:3072 sc1
    buffer_load_dwordx4 v[16:19], v226, s[44:47], s73 offen offset:0 sc1
    buffer_load_dwordx4 v[20:23], v226, s[44:47], s73 offen offset:1024 sc1
    buffer_load_dwordx4 v[24:27], v226, s[44:47], s73 offen offset:2048 sc1
    buffer_load_dwordx4 v[28:31], v226, s[44:47], s73 offen offset:3072 sc1
L_ne_19:
    s_cmp_eq_u32 s99, 4
    s_cbranch_scc0 L_ne_20
    s_mov_b32 s99, 1
    s_add_u32 s92, s92, 2
    buffer_load_dwordx4 v[32:35], v226, s[44:47], s74 offen offset:0 sc1
    buffer_load_dwordx4 v[36:39], v226, s[44:47], s74 offen offset:1024 sc1
    buffer_load_dwordx4 v[40:43], v226, s[44:47], s74 offen offset:2048 sc1
    buffer_load_dwordx4 v[44:47], v226, s[44:47], s74 offen offset:3072 sc1
    buffer_load_dwordx4 v[48:51], v226, s[44:47], s75 offen offset:0 sc1
    buffer_load_dwordx4 v[52:55], v226, s[44:47], s75 offen offset:1024 sc1
    buffer_load_dwordx4 v[56:59], v226, s[44:47], s75 offen offset:2048 sc1
    buffer_load_dwordx4 v[60:63], v226, s[44:47], s75 offen offset:3072 sc1
L_ne_20:
    v_add_u32 v199, s42, v226
    s_xor_b32 s8, s3, 1
    s_lshl_b32 s8, s8, 13
    v_add_u32 v200, s8, v226
    s_xor_b32 s8, s3, 2
    s_lshl_b32 s8, s8, 13
    v_add_u32 v201, s8, v226
    s_xor_b32 s8, s3, 3
    s_lshl_b32 s8, s8, 13
    v_add_u32 v202, s8, v226
    s_cmp_eq_u32 s92, 0
    s_cbranch_scc0 L_woc_22
    s_waitcnt vmcnt(0)
    s_branch L_wod_21
L_woc_22:
    s_cmp_eq_u32 s92, 2
    s_cbranch_scc0 L_woc_23
    s_waitcnt vmcnt(8)
    s_branch L_wod_21
L_woc_23:
    s_waitcnt vmcnt(16)
L_wod_21:
    s_mov_b32 s90, 400000
    ds_read_b64_tr_b16 v[128:129], v247 offset:0
    ds_read_b64_tr_b16 v[130:131], v247 offset:1024
    ds_read_b64_tr_b16 v[132:133], v248 offset:0
    ds_read_b64_tr_b16 v[134:135], v248 offset:1024
    ds_read_b64_tr_b16 v[136:137], v247 offset:2048
    ds_read_b64_tr_b16 v[138:139], v247 offset:3072
    ds_read_b64_tr_b16 v[140:141], v248 offset:2048
    ds_read_b64_tr_b16 v[142:143], v248 offset:3072
    ds_read_b64_tr_b16 v[144:145], v247 offset:4096
    ds_read_b64_tr_b16 v[146:147], v247 offset:5120
    ds_read_b64_tr_b16 v[148:149], v248 offset:4096
    ds_read_b64_tr_b16 v[150:151], v248 offset:5120
    ds_read_b64_tr_b16 v[152:153], v247 offset:6144
    ds_read_b64_tr_b16 v[154:155], v247 offset:7168
    ds_read_b64_tr_b16 v[156:157], v248 offset:6144
    ds_read_b64_tr_b16 v[158:159], v248 offset:7168
    ds_read_b64_tr_b16 v[160:161], v247 offset:32768
    ds_read_b64_tr_b16 v[162:163], v247 offset:33792
    ds_read_b64_tr_b16 v[164:165], v248 offset:32768
    ds_read_b64_tr_b16 v[166:167], v248 offset:33792
    ds_read_b64_tr_b16 v[168:169], v247 offset:34816
    ds_read_b64_tr_b16 v[170:171], v247 offset:35840
    ds_read_b64_tr_b16 v[172:173], v248 offset:34816
    ds_read_b64_tr_b16 v[174:175], v248 offset:35840
    ds_read_b64_tr_b16 v[176:177], v247 offset:36864
    ds_read_b64_tr_b16 v[178:179], v247 offset:37888
    ds_read_b64_tr_b16 v[180:181], v248 offset:36864
    ds_read_b64_tr_b16 v[182:183], v248 offset:37888
    ds_read_b64_tr_b16 v[184:185], v247 offset:38912
    ds_read_b64_tr_b16 v[186:187], v247 offset:39936
    ds_read_b64_tr_b16 v[188:189], v248 offset:38912
    ds_read_b64_tr_b16 v[190:191], v248 offset:39936
L_top_24:
    s_mov_b32 s92, 0
    s_cmp_lg_u32 s98, 0
    s_cbranch_scc1 L_sk_26
    global_load_dword v240, v230, s[40:41] sc1
    s_add_u32 s92, s92, 1
L_sk_26:
    s_cmp_lg_u32 s99, 0
    s_cbranch_scc1 L_sk_27
    global_load_dword v241, v231, s[40:41] sc1
    s_add_u32 s92, s92, 1
L_sk_27:
    s_bitcmp1_b32 s98, 0
    s_cbranch_scc0 L_np_28
    s_cmp_eq_u32 s98, 3
    s_cbranch_scc1 L_w_31
    s_cmp_eq_u32 s99, 1
    s_cbranch_scc1 L_w11_30
    s_cmp_eq_u32 s92, 0
    s_cbranch_scc0 L_w1_29
    s_waitcnt vmcnt(0)
    s_branch L_w_31
L_w11_30:
    s_waitcnt vmcnt(8)
    s_branch L_w_31
L_w1_29:
    s_waitcnt vmcnt(1)
L_w_31:
    s_mov_b32 s98, 2
    s_waitcnt lgkmcnt(0)
    v_mfma_f32_32x32x16_bf16 v[64:79], v[128:131], v[0:3], 0
    v_mfma_f32_32x32x16_bf16 v[80:95], v[132:135], v[0:3], 0
    v_mfma_f32_32x32x16_bf16 v[64:79], v[136:139], v[4:7], v[64:79]
    v_mfma_f32_32x32x16_bf16 v[80:95], v[140:143], v[4:7], v[80:95]
    v_mfma_f32_32x32x16_bf16 v[64:79], v[144:147], v[8:11], v[64:79]
    v_mfma_f32_32x32x16_bf16 v[80:95], v[148:151], v[8:11], v[80:95]
    v_mfma_f32_32x32x16_bf16 v[64:79], v[152:155], v[12:15], v[64:79]
    v_mfma_f32_32x32x16_bf16 v[80:95], v[156:159], v[12:15], v[80:95]
    v_mfma_f32_32x32x16_bf16 v[64:79], v[160:163], v[16:19], v[64:79]
    v_mfma_f32_32x32x16_bf16 v[80:95], v[164:167], v[16:19], v[80:95]
    v_mfma_f32_32x32x16_bf16 v[64:79], v[168:171], v[20:23], v[64:79]
    v_mfma_f32_32x32x16_bf16 v[80:95], v[172:175], v[20:23], v[80:95]
    v_mfma_f32_32x32x16_bf16 v[64:79], v[176:179], v[24:27], v[64:79]
    v_mfma_f32_32x32x16_bf16 v[80:95], v[180:183], v[24:27], v[80:95]
    v_mfma_f32_32x32x16_bf16 v[64:79], v[184:187], v[28:31], v[64:79]
    v_mfma_f32_32x32x16_bf16 v[80:95], v[188:191], v[28:31], v[80:95]
L_np_28:
    s_bitcmp1_b32 s99, 0
    s_cbranch_scc0 L_np_32
    s_cmp_eq_u32 s99, 3
    s_cbranch_scc1 L_w_35
    s_cmp_eq_u32 s92, 0
    s_cbranch_scc0 L_w1_33
    s_waitcnt vmcnt(0)
    s_branch L_w_35
L_w1_33:
    s_waitcnt vmcnt(1)
L_w_35:
    s_mov_b32 s99, 2
    s_waitcnt lgkmcnt(0)
    v_mfma_f32_32x32x16_bf16 v[96:111], v[128:131], v[32:35], 0
    v_mfma_f32_32x32x16_bf16 v[112:127], v[132:135], v[32:35], 0
    v_mfma_f32_32x32x16_bf16 v[96:111], v[136:139], v[36:39], v[96:111]
    v_mfma_f32_32x32x16_bf16 v[112:127], v[140:143], v[36:39], v[112:127]
    v_mfma_f32_32x32x16_bf16 v[96:111], v[144:147], v[40:43], v[96:111]
    v_mfma_f32_32x32x16_bf16 v[112:127], v[148:151], v[40:43], v[112:127]
    v_mfma_f32_32x32x16_bf16 v[96:111], v[152:155], v[44:47], v[96:111]
    v_mfma_f32_32x32x16_bf16 v[112:127], v[156:159], v[44:47], v[112:127]
    v_mfma_f32_32x32x16_bf16 v[96:111], v[160:163], v[48:51], v[96:111]
    v_mfma_f32_32x32x16_bf16 v[112:127], v[164:167], v[48:51], v[112:127]
    v_mfma_f32_32x32x16_bf16 v[96:111], v[168:171], v[52:55], v[96:111]
    v_mfma_f32_32x32x16_bf16 v[112:127], v[172:175], v[52:55], v[112:127]
    v_mfma_f32_32x32x16_bf16 v[96:111], v[176:179], v[56:59], v[96:111]
    v_mfma_f32_32x32x16_bf16 v[112:127], v[180:183], v[56:59], v[112:127]
    v_mfma_f32_32x32x16_bf16 v[96:111], v[184:187], v[60:63], v[96:111]
    v_mfma_f32_32x32x16_bf16 v[112:127], v[188:191], v[60:63], v[112:127]
L_np_32:
    s_and_b32 s8, s98, s99
    s_cmp_eq_u32 s8, 2
    s_cbranch_scc1 L_done_25
    s_waitcnt vmcnt(0)
    s_mov_b32 s9, 0
    s_cmp_lg_u32 s98, 0
    s_cbranch_scc1 L_nc_36
    v_cmp_ne_u32 vcc, s91, v240
    s_cmp_eq_u64 vcc, 0
    s_cbranch_scc0 L_nc_36
    s_mov_b32 s98, 1
    s_mov_b32 s9, 1
    buffer_load_dwordx4 v[0:3], v226, s[44:47], s72 offen offset:0 sc1
    buffer_load_dwordx4 v[4:7], v226, s[44:47], s72 offen offset:1024 sc1
    buffer_load_dwordx4 v[8:11], v226, s[44:47], s72 offen offset:2048 sc1
    buffer_load_dwordx4 v[12:15], v226, s[44:47], s72 offen offset:3072 sc1
    buffer_load_dwordx4 v[16:19], v226, s[44:47], s73 offen offset:0 sc1
    buffer_load_dwordx4 v[20:23], v226, s[44:47], s73 offen offset:1024 sc1
    buffer_load_dwordx4 v[24:27], v226, s[44:47], s73 offen offset:2048 sc1
    buffer_load_dwordx4 v[28:31], v226, s[44:47], s73 offen offset:3072 sc1
L_nc_36:
    s_cmp_lg_u32 s99, 0
    s_cbranch_scc1 L_nc_37
    v_cmp_ne_u32 vcc, s91, v241
    s_cmp_eq_u64 vcc, 0
    s_cbranch_scc0 L_nc_37
    s_mov_b32 s99, 1
    s_mov_b32 s9, 1
    buffer_load_dwordx4 v[32:35], v226, s[44:47], s74 offen offset:0 sc1
    buffer_load_dwordx4 v[36:39], v226, s[44:47], s74 offen offset:1024 sc1
    buffer_load_dwordx4 v[40:43], v226, s[44:47], s74 offen offset:2048 sc1
    buffer_load_dwordx4 v[44:47], v226, s[44:47], s74 offen offset:3072 sc1
    buffer_load_dwordx4 v[48:51], v226, s[44:47], s75 offen offset:0 sc1
    buffer_load_dwordx4 v[52:55], v226, s[44:47], s75 offen offset:1024 sc1
    buffer_load_dwordx4 v[56:59], v226, s[44:47], s75 offen offset:2048 sc1
    buffer_load_dwordx4 v[60:63], v226, s[44:47], s75 offen offset:3072 sc1
L_nc_37:
    s_cmp_lg_u32 s9, 0
    s_cbranch_scc1 L_nosl_38
    s_sleep 2
L_nosl_38:
    s_sub_u32 s90, s90, 1
    s_cmp_lg_u32 s90, 0
    s_cbranch_scc1 L_top_24
L_done_25:
    s_nop 6
    ds_write_b128 v199, v[80:83] offset:0
    ds_write_b128 v199, v[84:87] offset:1024
    ds_write_b128 v199, v[88:91] offset:2048
    ds_write_b128 v199, v[92:95] offset:3072
    ds_write_b128 v199, v[96:99] offset:4096
    ds_write_b128 v199, v[100:103] offset:5120
    ds_write_b128 v199, v[104:107] offset:6144
    ds_write_b128 v199, v[108:111] offset:7168
    ds_write_b128 v199, v[112:115] offset:32768
    ds_write_b128 v199, v[116:119] offset:33792
    ds_write_b128 v199, v[120:123] offset:34816
    ds_write_b128 v199, v[124:127] offset:35840
    v_mov_b32 v211, s91
    v_mov_b32 v215, s91
    v_mov_b32 v217, s91
    v_mov_b32 v219, s91
    s_waitcnt lgkmcnt(0)
    s_barrier
    ds_read_b128 v[0:3], v200 offset:0
    ds_read_b128 v[4:7], v200 offset:1024
    ds_read_b128 v[8:11], v200 offset:2048
    ds_read_b128 v[12:15], v200 offset:3072
    ds_read_b128 v[16:19], v201 offset:4096
    ds_read_b128 v[20:23], v201 offset:5120
    ds_read_b128 v[24:27], v201 offset:6144
    ds_read_b128 v[28:31], v201 offset:7168
    ds_read_b128 v[32:35], v202 offset:32768
    ds_read_b128 v[36:39], v202 offset:33792
    ds_read_b128 v[40:43], v202 offset:34816
    ds_read_b128 v[44:47], v202 offset:35840
    s_waitcnt lgkmcnt(4)
    v_pk_add_f32 v[0:1], v[0:1], v[16:17]
    v_pk_add_f32 v[2:3], v[2:3], v[18:19]
    v_pk_add_f32 v[4:5], v[4:5], v[20:21]
    v_pk_add_f32 v[6:7], v[6:7], v[22:23]
    v_pk_add_f32 v[8:9], v[8:9], v[24:25]
    v_pk_add_f32 v[10:11], v[10:11], v[26:27]
    v_pk_add_f32 v[12:13], v[12:13], v[28:29]
    v_pk_add_f32 v[14:15], v[14:15], v[30:31]
    v_pk_add_f32 v[64:65], v[64:65], v[0:1]
    v_pk_add_f32 v[66:67], v[66:67], v[2:3]
    v_pk_add_f32 v[68:69], v[68:69], v[4:5]
    v_pk_add_f32 v[70:71], v[70:71], v[6:7]
    v_pk_add_f32 v[72:73], v[72:73], v[8:9]
    v_pk_add_f32 v[74:75], v[74:75], v[10:11]
    v_pk_add_f32 v[76:77], v[76:77], v[12:13]
    v_pk_add_f32 v[78:79], v[78:79], v[14:15]
    s_waitcnt lgkmcnt(0)
    v_pk_add_f32 v[64:65], v[64:65], v[32:33]
    v_pk_add_f32 v[66:67], v[66:67], v[34:35]
    v_pk_add_f32 v[68:69], v[68:69], v[36:37]
    v_pk_add_f32 v[70:71], v[70:71], v[38:39]
    v_pk_add_f32 v[72:73], v[72:73], v[40:41]
    v_pk_add_f32 v[74:75], v[74:75], v[42:43]
    v_pk_add_f32 v[76:77], v[76:77], v[44:45]
    v_pk_add_f32 v[78:79], v[78:79], v[46:47]
    v_cvt_pk_bf16_f32 v208, v64, v65
    v_cvt_pk_bf16_f32 v209, v66, v67
    v_cvt_pk_bf16_f32 v210, v72, v73
    v_cvt_pk_bf16_f32 v216, v74, v75
    v_cvt_pk_bf16_f32 v212, v68, v69
    v_cvt_pk_bf16_f32 v213, v70, v71
    v_cvt_pk_bf16_f32 v214, v76, v77
    v_cvt_pk_bf16_f32 v218, v78, v79
    v_permlane32_swap_b32 v208, v210
    v_permlane32_swap_b32 v209, v216
    v_permlane32_swap_b32 v212, v214
    v_permlane32_swap_b32 v213, v218
    buffer_store_dwordx4 v[208:211], v226, s[16:19], s76 offen offset:0 sc1
    buffer_store_dwordx4 v[212:215], v226, s[16:19], s76 offen offset:1024 sc1
    buffer_store_dwordx4 v[216:219], v226, s[16:19], s76 offen offset:2048 sc1
    s_mov_b32 s90, 400000
    v_and_b32 v205, 7, v255
    v_lshlrev_b32 v205, 14, v205
    s_lshr_b32 s8, s4, 2
    s_lshl_b32 s8, s8, 13
    s_and_b32 s9, s3, 1
    s_lshl_b32 s9, s9, 12
    s_add_u32 s8, s8, s9
    s_add_u32 s8, s8, 3068
    v_add_u32 v205, s8, v205
    s_cmp_lg_u32 s3, 0
    s_cbranch_scc1 L_yw_43
L_yn_41:
    buffer_load_dword v206, v205, s[16:19], 0 offen sc1
    s_waitcnt vmcnt(0)
    v_cmp_ne_u32 vcc, s91, v206
    s_cmp_eq_u64 vcc, 0
    s_cbranch_scc1 L_ynd_42
    s_sleep 2
    s_sub_u32 s90, s90, 1
    s_cmp_lg_u32 s90, 0
    s_cbranch_scc1 L_yn_41
L_ynd_42:
L_yw_43:
    s_barrier
    s_mov_b32 s90, 400000
L_p2_39:
    buffer_load_dwordx4 v[16:19], v227, s[16:19], 0 offen sc1
    buffer_load_dwordx4 v[20:23], v227, s[16:19], s77 offen sc1
    buffer_load_dwordx2 v[24:25], v228, s[16:19], 0 offen sc1
    buffer_load_dwordx2 v[26:27], v228, s[16:19], s77 offen sc1
    s_waitcnt vmcnt(0)
    v_min3_u32 v203, v19, v23, v25
    v_max3_u32 v204, v19, v23, v25
    v_min_u32 v203, v203, v27
    v_max_u32 v204, v204, v27
    v_xor_b32 v203, s91, v203
    v_xor_b32 v204, s91, v204
    v_or_b32 v203, v203, v204
    v_cmp_ne_u32 vcc, 0, v203
    s_cmp_eq_u64 vcc, 0
    s_cbranch_scc1 L_p2d_40
    s_sleep 2
    s_sub_u32 s90, s90, 1
    s_cmp_lg_u32 s90, 0
    s_cbranch_scc1 L_p2_39
L_p2d_40:
    v_mov_b32 v19, v24
    v_mov_b32 v23, v26
    s_mov_b32 s8, 0xffff0000
    v_lshlrev_b32 v32, 16, v16
    v_and_b32 v33, s8, v16
    v_lshlrev_b32 v34, 16, v17
    v_and_b32 v35, s8, v17
    v_lshlrev_b32 v36, 16, v18
    v_and_b32 v37, s8, v18
    v_lshlrev_b32 v38, 16, v19
    v_and_b32 v39, s8, v19
    v_lshlrev_b32 v40, 16, v20
    v_and_b32 v41, s8, v20
    v_lshlrev_b32 v42, 16, v21
    v_and_b32 v43, s8, v21
    v_lshlrev_b32 v44, 16, v22
    v_and_b32 v45, s8, v22
    v_lshlrev_b32 v46, 16, v23
    v_and_b32 v47, s8, v23
    v_add_f32 v32, v32, v40
    v_add_f32 v33, v33, v41
    v_add_f32 v34, v34, v42
    v_add_f32 v35, v35, v43
    v_add_f32 v36, v36, v44
    v_add_f32 v37, v37, v45
    v_add_f32 v38, v38, v46
    v_add_f32 v39, v39, v47
    v_permlane32_swap_b32 v32, v36
    v_permlane32_swap_b32 v33, v37
    v_permlane32_swap_b32 v34, v38
    v_permlane32_swap_b32 v35, v39
    v_add_f32 v32, v32, v36
    v_add_f32 v33, v33, v37
    v_add_f32 v34, v34, v38
    v_add_f32 v35, v35, v39
    s_nop 0
    v_permlane16_swap_b32 v32, v34
    v_permlane16_swap_b32 v33, v35
    v_add_f32 v32, v32, v34
    v_add_f32 v33, v33, v35
    v_cvt_pk_bf16_f32 v32, v32, v33
    global_store_dword v229, v32, s[36:37]
    s_branch L_end
L_end:
L_exit:
    s_endpgm

.section .rodata,"a"
.p2align 6
.amdhsa_kernel concat_heads__gqa_block_cached__mha_block_cached__near_ridge_kernel
  .amdhsa_next_free_vgpr 256
  .amdhsa_next_free_sgpr 100
  .amdhsa_accum_offset 256
  .amdhsa_group_segment_fixed_size 0
  .amdhsa_kernarg_size 104
  .amdhsa_user_sgpr_count 2
  .amdhsa_user_sgpr_kernarg_segment_ptr 1
  .amdhsa_system_sgpr_workgroup_id_x 1
.end_amdhsa_kernel
```
